```python
import torch

def _softmax(x, axis=-1):
    return torch.softmax(x, dim=axis)
def _gelu(x):
    return torch.nn.functional.gelu(x, approximate="tanh")
def _silu(x):
    return torch.nn.functional.silu(x)
def _sigmoid(x):
    return torch.sigmoid(x)
def _layernorm(x, axis=-1, eps=1e-5):
    m = x.mean(dim=axis, keepdim=True)
    v = x.var(dim=axis, keepdim=True, unbiased=False)
    return (x - m) / torch.sqrt(v + eps)
def _scatter_add(tgt, idx, src, axis=0):
    return tgt.clone().index_add_(axis, idx, src)
def _segment_sum(src, seg, n):
    out = torch.zeros((n,) + src.shape[1:], dtype=src.dtype)
    return out.index_add_(0, seg, src)
def _pad(x, pw):
    flat = tuple(v for pair in reversed(pw) for v in pair)
    return torch.nn.functional.pad(x, flat)

kernel_name = 'sequential_preLN__gqa_block_cached__mixer_token_mlp__decode'

def setup_inputs():

    _w = (lambda a: (lambda t: t.to(torch.bfloat16) if t.is_floating_point() else t)(torch.as_tensor(a)))
    def _A_setup():
        B, Sq, D = 2, 1, 576
        Hq, Hkv, Sk, Dh = 32, 16, 32768, 128
        assert Hq % Hkv == 0, (Hq, Hkv)
        return {
            "x": _w((lambda *s: torch.randn(*s, dtype=torch.bfloat16) * 0.05)(B, Sq, D)),
            "k_cache": _w((lambda *s: torch.randn(*s, dtype=torch.bfloat16) * 3.2)(B, Hkv, Sk, Dh)),
            "v_cache": _w((lambda *s: torch.randn(*s, dtype=torch.bfloat16) * 0.8)(B, Hkv, Sk, Dh)),
            "wq": _w((lambda *s: torch.randn(*s, dtype=torch.bfloat16) * 3.2)(D, Hq * Dh) * (D ** -0.5)),
            "wo": _w((lambda *s: torch.randn(*s, dtype=torch.bfloat16) * 0.8)(Hq * Dh, D) * ((Hq * Dh) ** -0.5)),
        }
    _A_in = _A_setup()

    def _B_setup():
        B, S, D, F = 2, 1, 576, 4608
        return {
            "x": _w((lambda *s: torch.randn(*s, dtype=torch.bfloat16) * 0.05)(B, S, D)),
            "w1": _w((lambda *s: torch.randn(*s, dtype=torch.bfloat16) * 0.8)(S, F) * (S ** -0.5)),
            "b1": _w((lambda *s: torch.randn(*s, dtype=torch.bfloat16) * 0.8)(F) * 0.02),
            "w2": _w((lambda *s: torch.randn(*s, dtype=torch.bfloat16) * 0.8)(F, S) * (F ** -0.5)),
            "b2": _w((lambda *s: torch.randn(*s, dtype=torch.bfloat16) * 0.8)(S) * 0.02),
        }
    _B_in = _B_setup()

    return {
        "A_x": _A_in["x"],
        "A_k_cache": _A_in["k_cache"],
        "A_v_cache": _A_in["v_cache"],
        "A_wq": _A_in["wq"],
        "A_wo": _A_in["wo"],
        "B_x": _B_in["x"],
        "B_w1": _B_in["w1"],
        "B_b1": _B_in["b1"],
        "B_w2": _B_in["w2"],
        "B_b2": _B_in["b2"],
    }

def reference(A_x, A_k_cache, A_v_cache, A_wq, A_wo, B_x, B_w1, B_b1, B_w2, B_b2):
    def _A_ref(x, k_cache, v_cache, wq, wo):
        B, Sq, D = x.shape
        Hq, Dh = 32, 128
        Hkv = k_cache.shape[1]
        rep = Hq // Hkv
        q = (lambda x, *d: x.permute(*d))((x @ wq).reshape(B, Sq, Hq, Dh), 0, 2, 1, 3)
        k = (lambda x, n, axis: torch.repeat_interleave(x, n, dim=axis))(k_cache, rep, axis=1)
        v = (lambda x, n, axis: torch.repeat_interleave(x, n, dim=axis))(v_cache, rep, axis=1)
        scores = torch.einsum("bhqd,bhkd->bhqk", q, k) * (Dh ** -0.5)
        p = _softmax(scores, axis=-1)
        o = torch.einsum("bhqk,bhkd->bhqd", p, v)
        return (lambda x, *d: x.permute(*d))(o, 0, 2, 1, 3).reshape(B, Sq, Hq * Dh) @ wo

    def _B_ref(x, w1, b1, w2, b2):
        B, S, D = x.shape
        h = _layernorm(x, axis=-1)
        u = torch.einsum("bsd,sf->bdf", h, w1) + b1
        u = _gelu(u)
        y = torch.einsum("bdf,fs->bds", u, w2) + b2
        return (lambda x, *d: x.permute(*d))(y, 0, 2, 1)

    x = A_x
    h = x + _A_ref(_layernorm(x, axis=-1), A_k_cache, A_v_cache, A_wq, A_wo)
    h2 = h + _B_ref(_layernorm(h, axis=-1), B_w1, B_b1, B_w2, B_b2)
    return h2
```

```asm
; @launch grid=(256,1,1) block=(512,1,1) lds=143360
.amdgcn_target "amdgcn-amd-amdhsa--gfx950"
.text
.globl sequential_preLN__gqa_block_cached__mixer_token_mlp__decode_kernel
.p2align 8
.type sequential_preLN__gqa_block_cached__mixer_token_mlp__decode_kernel,@function
sequential_preLN__gqa_block_cached__mixer_token_mlp__decode_kernel:
    s_cmp_ge_u32 s2, 256
    s_cbranch_scc1 L_end
    s_load_dwordx16 s[4:19], s[0:1], 0
    s_load_dwordx8 s[20:27], s[0:1], 64
    s_load_dwordx2 s[28:29], s[0:1], 96
    v_and_b32 v1, 63, v0
    v_lshrrev_b32 v2, 6, v0
    s_nop 0
    v_readfirstlane_b32 s3, v2
    s_mov_b32 s30, 0
    s_bitcmp1_b32 s2, 0
    s_cselect_b32 s31, 5, 0
    s_xor_b32 s30, s30, s31
    s_bitcmp1_b32 s2, 1
    s_cselect_b32 s31, 14, 0
    s_xor_b32 s30, s30, s31
    s_bitcmp1_b32 s2, 2
    s_cselect_b32 s31, 8, 0
    s_xor_b32 s30, s30, s31
    s_bitcmp1_b32 s2, 3
    s_cselect_b32 s31, 4, 0
    s_xor_b32 s30, s30, s31
    s_bitcmp1_b32 s2, 4
    s_cselect_b32 s31, 16, 0
    s_xor_b32 s30, s30, s31
    s_lshr_b32 s31, s2, 5
    s_lshr_b32 s32, s30, 4
    s_and_b32 s33, s30, 15
    s_cmp_ge_u32 s3, 4
    s_cbranch_scc1 L_helper
    s_setprio 3
    v_lshrrev_b32 v9, 3, v1
    v_lshlrev_b32 v10, 13, v9
    v_and_b32 v11, 7, v1
    v_lshl_add_u32 v10, v11, 4, v10
    s_lshr_b32 s86, s31, 2
    s_lshl_b32 s53, s32, 1
    s_add_u32 s86, s86, s53
    s_mul_i32 s86, s86, 1179648
    s_lshl_b32 s53, s33, 9
    s_add_u32 s86, s86, s53
    s_and_b32 s53, s31, 3
    s_lshl_b32 s53, s53, 7
    s_add_u32 s86, s86, s53
    s_lshl_b32 s53, s3, 16
    s_add_u32 s86, s86, s53
    s_lshl_b32 s87, s3, 10
    s_add_u32 s87, s87, 110592
    s_mov_b32 s42, 4718592
    s_mov_b32 s43, 0x20000
    s_waitcnt lgkmcnt(0)
    s_mov_b32 s40, s10
    s_and_b32 s41, s11, 0xffff
    s_mov_b32 m0, s87
    s_add_u32 s87, s87, 4096
    buffer_load_dwordx4 v10, s[40:43], s86 offen nt lds
    s_add_u32 s86, s86, 0x40000
    s_mov_b32 m0, s87
    s_add_u32 s87, s87, 4096
    buffer_load_dwordx4 v10, s[40:43], s86 offen nt lds
    s_add_u32 s86, s86, 0x40000
    s_mov_b32 m0, s87
    s_add_u32 s87, s87, 4096
    buffer_load_dwordx4 v10, s[40:43], s86 offen nt lds
    s_add_u32 s86, s86, 0x40000
    s_mov_b32 m0, s87
    s_add_u32 s87, s87, 4096
    buffer_load_dwordx4 v10, s[40:43], s86 offen nt lds
    s_add_u32 s86, s86, 0x40000
    v_lshrrev_b32 v12, 3, v1
    v_mul_u32_u24 v12, 1152, v12
    v_and_b32 v13, 7, v1
    v_lshl_add_u32 v12, v13, 4, v12
    v_mul_u32_u24 v13, 1152, v1
    s_lshl_b32 s89, s33, 8
    s_lshl_b32 s55, s32, 7
    s_add_u32 s89, s89, s55
    s_and_b32 s53, s3, 1
    s_lshl_b32 s88, s53, 6
    s_add_u32 s88, s88, s89
    s_mul_i32 s88, s88, 1152
    s_lshl_b32 s55, s31, 4
    s_add_u32 s88, s88, s55
    s_add_u32 s88, s88, 1024
    s_lshl_b32 s55, s3, 5
    s_add_u32 s89, s89, s55
    s_mul_i32 s89, s89, 1152
    s_lshl_b32 s55, s31, 7
    s_add_u32 s89, s89, s55
    s_lshl_b32 s53, s53, 10
    s_add_u32 s53, s53, 104448
    s_mov_b32 s98, 4718592
    s_mov_b32 s99, 0x20000
    s_mov_b32 s96, s12
    s_and_b32 s97, s13, 0xffff
    s_lshl_b32 s57, s3, 12
    s_add_u32 s57, s57, 88064
    s_cmp_ge_u32 s3, 2
    s_cbranch_scc1 L_preb
    s_mov_b32 m0, s87
    s_nop 0
    buffer_load_dwordx4 v10, s[40:43], s86 offen nt lds
    s_branch L_prec
L_preb:
    s_mov_b32 m0, s53
    s_nop 0
    buffer_load_dwordx4 v13, s[96:99], s88 offen nt lds
L_prec:
    s_mov_b32 m0, s57
    s_add_u32 s57, s57, 1024
    buffer_load_dwordx4 v12, s[96:99], s89 offen nt lds
    s_add_u32 s89, s89, 9216
    s_mov_b32 m0, s57
    s_add_u32 s57, s57, 1024
    buffer_load_dwordx4 v12, s[96:99], s89 offen nt lds
    s_add_u32 s89, s89, 9216
    s_mov_b32 m0, s57
    s_add_u32 s57, s57, 1024
    buffer_load_dwordx4 v12, s[96:99], s89 offen nt lds
    s_add_u32 s89, s89, 9216
    s_mov_b32 m0, s57
    s_add_u32 s57, s57, 1024
    buffer_load_dwordx4 v12, s[96:99], s89 offen nt lds
    s_add_u32 s89, s89, 9216
    s_barrier
    v_lshlrev_b32 v3, 4, v1
    v_and_b32 v2, 3, v1
    v_lshlrev_b32 v2, 4, v2
    v_lshrrev_b32 v4, 4, v1
    v_lshl_add_u32 v2, v4, 6, v2
    v_and_b32 v35, 0xff, v3
    v_bfe_i32 v4, v1, 2, 1
    v_and_b32 v4, 0x00210200, v4
    v_xor_b32 v2, v2, v4
    v_bfe_i32 v4, v1, 3, 1
    v_and_b32 v4, 0x00210300, v4
    v_xor_b32 v2, v2, v4
    v_bfe_i32 v4, v1, 4, 1
    v_and_b32 v4, 0x00210200, v4
    v_xor_b32 v35, v35, v4
    v_bfe_i32 v4, v1, 5, 1
    v_and_b32 v4, 0x00210300, v4
    v_xor_b32 v35, v35, v4
    s_mov_b32 s46, 0
    s_mov_b32 s45, 0
    s_bitcmp1_b32 s2, 0
    s_cselect_b32 s47, 0x02ec9300, 0
    s_cselect_b32 s44, 33, 0
    s_add_u32 s45, s45, s44
    s_xor_b32 s46, s46, s47
    s_bitcmp1_b32 s2, 1
    s_cselect_b32 s47, 0x07298100, 0
    s_cselect_b32 s44, 17, 0
    s_add_u32 s45, s45, s44
    s_xor_b32 s46, s46, s47
    s_bitcmp1_b32 s2, 2
    s_cselect_b32 s47, 0x04001100, 0
    s_cselect_b32 s44, 36, 0
    s_add_u32 s45, s45, s44
    s_xor_b32 s46, s46, s47
    s_bitcmp1_b32 s2, 3
    s_cselect_b32 s47, 0x02469400, 0
    s_xor_b32 s46, s46, s47
    s_bitcmp1_b32 s2, 4
    s_cselect_b32 s47, 0x08380300, 0
    s_xor_b32 s46, s46, s47
    s_bitcmp1_b32 s2, 5
    s_cselect_b32 s47, 0x00293100, 0
    s_xor_b32 s46, s46, s47
    s_bitcmp1_b32 s2, 6
    s_cselect_b32 s47, 0x00283500, 0
    s_xor_b32 s46, s46, s47
    s_bitcmp1_b32 s2, 7
    s_cselect_b32 s47, 0x0073cc00, 0
    s_cselect_b32 s44, 48, 0
    s_add_u32 s45, s45, s44
    s_xor_b32 s46, s46, s47
    s_bitcmp1_b32 s3, 0
    s_cselect_b32 s47, 0x00052700, 0
    s_xor_b32 s46, s46, s47
    s_bitcmp1_b32 s3, 1
    s_cselect_b32 s47, 0x00299300, 0
    s_xor_b32 s46, s46, s47
    s_bitcmp1_b32 s45, 0
    s_cselect_b32 s47, 0x00200100, 0
    s_xor_b32 s46, s46, s47
    s_bitcmp1_b32 s45, 1
    s_cselect_b32 s47, 0x00680300, 0
    s_xor_b32 s46, s46, s47
    s_bitcmp1_b32 s45, 2
    s_cselect_b32 s47, 0x00004400, 0
    s_xor_b32 s46, s46, s47
    s_bitcmp1_b32 s45, 4
    s_cselect_b32 s47, 0x0038d400, 0
    s_xor_b32 s46, s46, s47
    s_bitcmp1_b32 s45, 5
    s_cselect_b32 s47, 0x00238500, 0
    s_xor_b32 s46, s46, s47
    s_mov_b32 s36, s6
    s_and_b32 s37, s7, 0xffff
    s_mov_b32 s38, 268435456
    s_mov_b32 s39, 0x20000
    s_mov_b32 s40, s8
    s_and_b32 s41, s9, 0xffff
    s_mov_b32 s42, 268435456
    s_mov_b32 s43, 0x20000
    v_and_b32 v28, 1, v1
    v_lshlrev_b32 v28, 4, v28
    v_mov_b32 v36, 0xffff
    v_lshlrev_b32 v28, v28, v36
    v_bfe_u32 v39, v1, 1, 2
    v_cmp_eq_u32 vcc, 0, v39
    s_nop 1
    v_cndmask_b32 v36, 0, v28, vcc
    v_cmp_eq_u32 vcc, 1, v39
    s_nop 1
    v_cndmask_b32 v37, 0, v28, vcc
    v_cmp_eq_u32 vcc, 2, v39
    s_nop 1
    v_cndmask_b32 v38, 0, v28, vcc
    v_cmp_eq_u32 vcc, 3, v39
    s_nop 1
    v_cndmask_b32 v39, 0, v28, vcc
    s_lshl_b32 s47, s3, 14
    s_add_u32 s47, s47, 16384
    v_lshl_add_u32 v54, v1, 2, s47
    v_mov_b32 v55, v54
    v_mov_b32 v53, 0xff800000
    v_mov_b32 v40, 0
    v_mov_b32 v41, 0
    v_mov_b32 v42, 0
    v_mov_b32 v43, 0
    v_bfe_u32 v28, v1, 3, 1
    v_lshlrev_b32 v29, 8, v28
    v_lshrrev_b32 v30, 4, v1
    v_lshl_add_u32 v29, v30, 6, v29
    v_and_b32 v30, 3, v1
    v_lshl_add_u32 v29, v30, 4, v29
    v_add_u32 v29, 81920, v29
    v_lshlrev_b32 v56, 2, v28
    v_add_u32 v56, 82432, v56
    v_and_b32 v30, 4, v1
    v_cmp_eq_u32 s[48:49], 0, v30
    s_mov_b32 s50, 0x3db504f3
    s_mov_b32 s51, 0x3fb8aa3b
    s_mov_b32 s52, 0xffff0000
    v_mov_b32 v25, 82816
    s_mov_b32 s54, 524288
    s_lshl_b32 s47, s3, 2
    s_add_u32 s47, s47, 82832
    v_mov_b32 v24, s47
    v_xor_b32 v52, s46, v2
    s_waitcnt vmcnt(8)
    buffer_load_dwordx4 v[64:67], v52, s[36:39], 0 offen nt
    s_xor_b32 s59, s46, 0x00000300
    v_xor_b32 v52, s59, v2
    s_waitcnt vmcnt(8)
    buffer_load_dwordx4 v[68:71], v52, s[36:39], 0 offen nt
    s_xor_b32 s59, s46, 0x00018000
    v_xor_b32 v52, s59, v2
    s_waitcnt vmcnt(7)
    buffer_load_dwordx4 v[72:75], v52, s[36:39], 0 offen nt
    s_xor_b32 s59, s46, 0x00018300
    v_xor_b32 v52, s59, v2
    s_waitcnt vmcnt(7)
    buffer_load_dwordx4 v[76:79], v52, s[36:39], 0 offen nt
    ds_write_b32 v24, v24
    s_mov_b32 s60, 0x00200100
    s_mov_b32 s61, 0x00480200
    s_mov_b32 s62, 0x00484600
    s_mov_b32 s63, 0x0061c500
    s_mov_b32 s64, 0x00591100
    s_mov_b32 s65, 0x007a9400
    s_add_u32 s45, s45, 1
    s_or_b32 s44, s45, 32
    s_ff1_i32_b32 m0, s44
    s_nop 0
    s_movrels_b32 s44, s60
    s_xor_b32 s46, s46, s44
    v_xor_b32 v52, s46, v2
    s_waitcnt vmcnt(6)
    buffer_load_dwordx4 v[80:83], v52, s[36:39], 0 offen nt
    s_xor_b32 s59, s46, 0x00000300
    v_xor_b32 v52, s59, v2
    s_waitcnt vmcnt(6)
    buffer_load_dwordx4 v[84:87], v52, s[36:39], 0 offen nt
    s_xor_b32 s59, s46, 0x00018000
    v_xor_b32 v52, s59, v2
    s_waitcnt vmcnt(5)
    buffer_load_dwordx4 v[88:91], v52, s[36:39], 0 offen nt
    s_xor_b32 s59, s46, 0x00018300
    v_xor_b32 v52, s59, v2
    s_waitcnt vmcnt(5)
    buffer_load_dwordx4 v[92:95], v52, s[36:39], 0 offen nt
    s_add_u32 s45, s45, 1
    s_or_b32 s44, s45, 32
    s_ff1_i32_b32 m0, s44
    s_nop 0
    s_movrels_b32 s44, s60
    s_xor_b32 s46, s46, s44
    v_xor_b32 v52, s46, v2
    s_waitcnt vmcnt(5)
    buffer_load_dwordx4 v[96:99], v52, s[36:39], 0 offen nt
    s_xor_b32 s59, s46, 0x00000300
    v_xor_b32 v52, s59, v2
    s_waitcnt vmcnt(5)
    buffer_load_dwordx4 v[100:103], v52, s[36:39], 0 offen nt
    s_xor_b32 s59, s46, 0x00018000
    v_xor_b32 v52, s59, v2
    s_waitcnt vmcnt(5)
    buffer_load_dwordx4 v[104:107], v52, s[36:39], 0 offen nt
    s_xor_b32 s59, s46, 0x00018300
    v_xor_b32 v52, s59, v2
    s_waitcnt vmcnt(5)
    buffer_load_dwordx4 v[108:111], v52, s[36:39], 0 offen nt
    s_add_u32 s45, s45, 1
    s_or_b32 s44, s45, 32
    s_ff1_i32_b32 m0, s44
    s_nop 0
    s_movrels_b32 s44, s60
    s_xor_b32 s46, s46, s44
    v_xor_b32 v52, s46, v2
    s_waitcnt vmcnt(5)
    buffer_load_dwordx4 v[112:115], v52, s[36:39], 0 offen nt
    s_xor_b32 s59, s46, 0x00000300
    v_xor_b32 v52, s59, v2
    s_waitcnt vmcnt(5)
    buffer_load_dwordx4 v[116:119], v52, s[36:39], 0 offen nt
    s_xor_b32 s59, s46, 0x00018000
    v_xor_b32 v52, s59, v2
    s_waitcnt vmcnt(5)
    buffer_load_dwordx4 v[120:123], v52, s[36:39], 0 offen nt
    s_xor_b32 s59, s46, 0x00018300
    v_xor_b32 v52, s59, v2
    s_waitcnt vmcnt(5)
    buffer_load_dwordx4 v[124:127], v52, s[36:39], 0 offen nt
    s_add_u32 s45, s45, 1
    s_or_b32 s44, s45, 32
    s_ff1_i32_b32 m0, s44
    s_nop 0
    s_movrels_b32 s44, s60
    s_xor_b32 s46, s46, s44
    v_xor_b32 v52, s46, v2
    s_waitcnt vmcnt(5)
    buffer_load_dwordx4 v[128:131], v52, s[36:39], 0 offen nt
    s_xor_b32 s59, s46, 0x00000300
    v_xor_b32 v52, s59, v2
    s_waitcnt vmcnt(5)
    buffer_load_dwordx4 v[132:135], v52, s[36:39], 0 offen nt
    s_xor_b32 s59, s46, 0x00018000
    v_xor_b32 v52, s59, v2
    s_waitcnt vmcnt(5)
    buffer_load_dwordx4 v[136:139], v52, s[36:39], 0 offen nt
    s_xor_b32 s59, s46, 0x00018300
    v_xor_b32 v52, s59, v2
    s_waitcnt vmcnt(5)
    buffer_load_dwordx4 v[140:143], v52, s[36:39], 0 offen nt
    s_add_u32 s45, s45, 1
    s_or_b32 s44, s45, 32
    s_ff1_i32_b32 m0, s44
    s_nop 0
    s_movrels_b32 s44, s60
    s_xor_b32 s46, s46, s44
    v_xor_b32 v52, s46, v2
    s_waitcnt vmcnt(5)
    buffer_load_dwordx4 v[144:147], v52, s[36:39], 0 offen nt
    s_xor_b32 s59, s46, 0x00000300
    v_xor_b32 v52, s59, v2
    s_waitcnt vmcnt(5)
    buffer_load_dwordx4 v[148:151], v52, s[36:39], 0 offen nt
    s_xor_b32 s59, s46, 0x00018000
    v_xor_b32 v52, s59, v2
    s_waitcnt vmcnt(5)
    buffer_load_dwordx4 v[152:155], v52, s[36:39], 0 offen nt
    s_xor_b32 s59, s46, 0x00018300
    v_xor_b32 v52, s59, v2
    s_waitcnt vmcnt(5)
    buffer_load_dwordx4 v[156:159], v52, s[36:39], 0 offen nt
    s_add_u32 s45, s45, 1
    s_or_b32 s44, s45, 32
    s_ff1_i32_b32 m0, s44
    s_nop 0
    s_movrels_b32 s44, s60
    s_xor_b32 s46, s46, s44
    v_xor_b32 v52, s46, v2
    s_waitcnt vmcnt(5)
    buffer_load_dwordx4 v[160:163], v52, s[36:39], 0 offen nt
    s_xor_b32 s59, s46, 0x00000300
    v_xor_b32 v52, s59, v2
    s_waitcnt vmcnt(5)
    buffer_load_dwordx4 v[164:167], v52, s[36:39], 0 offen nt
    s_xor_b32 s59, s46, 0x00018000
    v_xor_b32 v52, s59, v2
    s_waitcnt vmcnt(5)
    buffer_load_dwordx4 v[168:171], v52, s[36:39], 0 offen nt
    s_xor_b32 s59, s46, 0x00018300
    v_xor_b32 v52, s59, v2
    s_waitcnt vmcnt(5)
    buffer_load_dwordx4 v[172:175], v52, s[36:39], 0 offen nt
    s_add_u32 s45, s45, 1
    s_or_b32 s44, s45, 32
    s_ff1_i32_b32 m0, s44
    s_nop 0
    s_movrels_b32 s44, s60
    s_xor_b32 s46, s46, s44
    v_xor_b32 v52, s46, v2
    s_waitcnt vmcnt(5)
    buffer_load_dwordx4 v[176:179], v52, s[36:39], 0 offen nt
    s_xor_b32 s59, s46, 0x00000300
    v_xor_b32 v52, s59, v2
    s_waitcnt vmcnt(5)
    buffer_load_dwordx4 v[180:183], v52, s[36:39], 0 offen nt
    s_xor_b32 s59, s46, 0x00018000
    v_xor_b32 v52, s59, v2
    s_waitcnt vmcnt(5)
    buffer_load_dwordx4 v[184:187], v52, s[36:39], 0 offen nt
    s_xor_b32 s59, s46, 0x00018300
    v_xor_b32 v52, s59, v2
    s_waitcnt vmcnt(5)
    buffer_load_dwordx4 v[188:191], v52, s[36:39], 0 offen nt
    s_add_u32 s45, s45, 1
    s_or_b32 s44, s45, 32
    s_ff1_i32_b32 m0, s44
    s_nop 0
    s_movrels_b32 s44, s60
    s_xor_b32 s46, s46, s44
    v_xor_b32 v52, s46, v2
    s_waitcnt vmcnt(5)
    buffer_load_dwordx4 v[192:195], v52, s[36:39], 0 offen nt
    s_xor_b32 s59, s46, 0x00000300
    v_xor_b32 v52, s59, v2
    s_waitcnt vmcnt(5)
    buffer_load_dwordx4 v[196:199], v52, s[36:39], 0 offen nt
    s_xor_b32 s59, s46, 0x00018000
    v_xor_b32 v52, s59, v2
    s_waitcnt vmcnt(5)
    buffer_load_dwordx4 v[200:203], v52, s[36:39], 0 offen nt
    s_xor_b32 s59, s46, 0x00018300
    v_xor_b32 v52, s59, v2
    s_waitcnt vmcnt(5)
    buffer_load_dwordx4 v[204:207], v52, s[36:39], 0 offen nt
    s_add_u32 s45, s45, 1
    s_or_b32 s44, s45, 32
    s_ff1_i32_b32 m0, s44
    s_nop 0
    s_movrels_b32 s44, s60
    s_xor_b32 s46, s46, s44
    v_xor_b32 v52, s46, v2
    s_waitcnt vmcnt(5)
    buffer_load_dwordx4 v[208:211], v52, s[36:39], 0 offen nt
    s_xor_b32 s59, s46, 0x00000300
    v_xor_b32 v52, s59, v2
    s_waitcnt vmcnt(5)
    buffer_load_dwordx4 v[212:215], v52, s[36:39], 0 offen nt
    s_xor_b32 s59, s46, 0x00018000
    v_xor_b32 v52, s59, v2
    s_waitcnt vmcnt(5)
    buffer_load_dwordx4 v[216:219], v52, s[36:39], 0 offen nt
    s_xor_b32 s59, s46, 0x00018300
    v_xor_b32 v52, s59, v2
    s_waitcnt vmcnt(5)
    buffer_load_dwordx4 v[220:223], v52, s[36:39], 0 offen nt
    s_add_u32 s45, s45, 1
    s_or_b32 s44, s45, 32
    s_ff1_i32_b32 m0, s44
    s_nop 0
    s_movrels_b32 s44, s60
    s_xor_b32 s46, s46, s44
    v_xor_b32 v52, s46, v2
    s_waitcnt vmcnt(5)
    buffer_load_dwordx4 v[224:227], v52, s[36:39], 0 offen nt
    s_xor_b32 s59, s46, 0x00000300
    v_xor_b32 v52, s59, v2
    s_waitcnt vmcnt(5)
    buffer_load_dwordx4 v[228:231], v52, s[36:39], 0 offen nt
    s_xor_b32 s59, s46, 0x00018000
    v_xor_b32 v52, s59, v2
    s_waitcnt vmcnt(5)
    buffer_load_dwordx4 v[232:235], v52, s[36:39], 0 offen nt
    s_xor_b32 s59, s46, 0x00018300
    v_xor_b32 v52, s59, v2
    s_waitcnt vmcnt(5)
    buffer_load_dwordx4 v[236:239], v52, s[36:39], 0 offen nt
    s_add_u32 s45, s45, 1
    s_or_b32 s44, s45, 32
    s_ff1_i32_b32 m0, s44
    s_nop 0
    s_movrels_b32 s44, s60
    s_xor_b32 s46, s46, s44
    v_xor_b32 v52, s46, v2
    s_waitcnt vmcnt(5)
    buffer_load_dwordx4 v[240:243], v52, s[36:39], 0 offen nt
    s_xor_b32 s59, s46, 0x00000300
    v_xor_b32 v52, s59, v2
    s_waitcnt vmcnt(5)
    buffer_load_dwordx4 v[244:247], v52, s[36:39], 0 offen nt
    s_xor_b32 s59, s46, 0x00018000
    v_xor_b32 v52, s59, v2
    s_waitcnt vmcnt(5)
    buffer_load_dwordx4 v[248:251], v52, s[36:39], 0 offen nt
    s_xor_b32 s59, s46, 0x00018300
    v_xor_b32 v52, s59, v2
    s_waitcnt vmcnt(5)
    buffer_load_dwordx4 v[252:255], v52, s[36:39], 0 offen nt
L_qw:
    ds_read_b64 v[26:27], v25
    ds_read_b128 v[12:15], v29
    s_waitcnt lgkmcnt(0)
    v_cmp_eq_u32 vcc, -1, v26
    s_nop 0
    s_cbranch_vccz L_qrdy
    s_sub_u32 s54, s54, 1
    s_cmp_lg_u32 s54, 0
    s_cbranch_scc1 L_qw
L_qrdy:
    v_readfirstlane_b32 s55, v26
    v_readfirstlane_b32 s35, v27
    v_cndmask_b32 v4, 0, v12, s[48:49]
    v_cndmask_b32 v8, v12, 0, s[48:49]
    v_cndmask_b32 v5, 0, v13, s[48:49]
    v_cndmask_b32 v9, v13, 0, s[48:49]
    v_cndmask_b32 v6, 0, v14, s[48:49]
    v_cndmask_b32 v10, v14, 0, s[48:49]
    v_cndmask_b32 v7, 0, v15, s[48:49]
    v_cndmask_b32 v11, v15, 0, s[48:49]
    s_getreg_b32 s56, hwreg(HW_REG_XCC_ID)
    s_and_b32 s56, s56, 1
    s_xor_b32 s56, s56, 1
    s_mov_b32 s57, 0
    s_mov_b64 vcc, s[56:57]
    s_waitcnt vmcnt(47)
    v_mfma_f32_16x16x32_bf16 v[12:15], v[64:67], v[4:7], 0
    s_waitcnt vmcnt(46)
    v_mfma_f32_16x16x32_bf16 v[12:15], v[68:71], v[8:11], v[12:15]
    s_add_u32 s45, s45, 1
    s_or_b32 s44, s45, 32
    s_ff1_i32_b32 m0, s44
    s_nop 0
    s_movrels_b32 s44, s60
    s_xor_b32 s46, s46, s44
    v_xor_b32 v52, s46, v2
    s_waitcnt vmcnt(4)
    buffer_load_dwordx4 v[64:67], v52, s[36:39], 0 offen nt
    v_mfma_f32_16x16x32_bf16 v[16:19], v[72:75], v[4:7], 0
    v_mfma_f32_16x16x32_bf16 v[16:19], v[76:79], v[8:11], v[16:19]
    v_mov_b32_dpp v28, v12 quad_perm:[0,0,0,0] row_mask:0xf bank_mask:0xf
    s_nop 1
    v_add_f32_dpp v28, v13, v28 quad_perm:[1,1,1,1] row_mask:0xf bank_mask:0xf
    s_nop 1
    v_add_f32_dpp v28, v14, v28 quad_perm:[2,2,2,2] row_mask:0xf bank_mask:0xf
    s_nop 1
    v_add_f32_dpp v28, v15, v28 quad_perm:[3,3,3,3] row_mask:0xf bank_mask:0xf
    v_mfma_f32_16x16x32_bf16 v[12:15], v[80:83], v[4:7], 0
    v_mov_b32_dpp v29, v16 quad_perm:[0,0,0,0] row_mask:0xf bank_mask:0xf
    s_nop 1
    v_add_f32_dpp v29, v17, v29 quad_perm:[1,1,1,1] row_mask:0xf bank_mask:0xf
    s_nop 1
    v_add_f32_dpp v29, v18, v29 quad_perm:[2,2,2,2] row_mask:0xf bank_mask:0xf
    s_nop 1
    v_add_f32_dpp v29, v19, v29 quad_perm:[3,3,3,3] row_mask:0xf bank_mask:0xf
    v_cvt_pk_bf16_f32 v31, 0, v28
    v_cvt_pk_bf16_f32 v32, 0, v29
    v_mul_f32 v31, s50, v31
    v_mul_f32 v32, s50, v32
    v_cvt_pk_bf16_f32 v30, v31, v32
    v_max3_f32 v53, v53, v31, v32
    ds_write_b32 v54, v30 offset:0
    s_xor_b32 s59, s46, 0x00000300
    v_xor_b32 v52, s59, v2
    s_waitcnt vmcnt(4)
    buffer_load_dwordx4 v[68:71], v52, s[36:39], 0 offen nt
    v_mfma_f32_16x16x32_bf16 v[12:15], v[84:87], v[8:11], v[12:15]
    v_mfma_f32_16x16x32_bf16 v[16:19], v[88:91], v[4:7], 0
    v_mfma_f32_16x16x32_bf16 v[16:19], v[92:95], v[8:11], v[16:19]
    s_nop 5
    v_mov_b32_dpp v28, v12 quad_perm:[0,0,0,0] row_mask:0xf bank_mask:0xf
    s_nop 1
    v_add_f32_dpp v28, v13, v28 quad_perm:[1,1,1,1] row_mask:0xf bank_mask:0xf
    s_nop 1
    v_add_f32_dpp v28, v14, v28 quad_perm:[2,2,2,2] row_mask:0xf bank_mask:0xf
    s_nop 1
    v_add_f32_dpp v28, v15, v28 quad_perm:[3,3,3,3] row_mask:0xf bank_mask:0xf
    s_xor_b32 s59, s46, 0x00018000
    v_xor_b32 v52, s59, v2
    s_waitcnt vmcnt(5)
    s_cbranch_vccnz 1
    s_waitcnt vmcnt(4)
    buffer_load_dwordx4 v[72:75], v52, s[36:39], 0 offen nt
    v_mfma_f32_16x16x32_bf16 v[12:15], v[96:99], v[4:7], 0
    v_mov_b32_dpp v29, v16 quad_perm:[0,0,0,0] row_mask:0xf bank_mask:0xf
    s_nop 1
    v_add_f32_dpp v29, v17, v29 quad_perm:[1,1,1,1] row_mask:0xf bank_mask:0xf
    s_nop 1
    v_add_f32_dpp v29, v18, v29 quad_perm:[2,2,2,2] row_mask:0xf bank_mask:0xf
    s_nop 1
    v_add_f32_dpp v29, v19, v29 quad_perm:[3,3,3,3] row_mask:0xf bank_mask:0xf
    v_cvt_pk_bf16_f32 v31, 0, v28
    v_cvt_pk_bf16_f32 v32, 0, v29
    v_mul_f32 v31, s50, v31
    v_mul_f32 v32, s50, v32
    v_cvt_pk_bf16_f32 v30, v31, v32
    v_max3_f32 v53, v53, v31, v32
    ds_write_b32 v54, v30 offset:256
    v_mfma_f32_16x16x32_bf16 v[12:15], v[100:103], v[8:11], v[12:15]
    v_mfma_f32_16x16x32_bf16 v[16:19], v[104:107], v[4:7], 0
    s_xor_b32 s59, s46, 0x00018300
    v_xor_b32 v52, s59, v2
    s_waitcnt vmcnt(4)
    buffer_load_dwordx4 v[76:79], v52, s[36:39], 0 offen nt
    v_mfma_f32_16x16x32_bf16 v[16:19], v[108:111], v[8:11], v[16:19]
    s_nop 1
    v_mov_b32_dpp v28, v12 quad_perm:[0,0,0,0] row_mask:0xf bank_mask:0xf
    s_nop 1
    v_add_f32_dpp v28, v13, v28 quad_perm:[1,1,1,1] row_mask:0xf bank_mask:0xf
    s_nop 1
    v_add_f32_dpp v28, v14, v28 quad_perm:[2,2,2,2] row_mask:0xf bank_mask:0xf
    s_nop 1
    v_add_f32_dpp v28, v15, v28 quad_perm:[3,3,3,3] row_mask:0xf bank_mask:0xf
    v_mfma_f32_16x16x32_bf16 v[12:15], v[112:115], v[4:7], 0
    v_mov_b32_dpp v29, v16 quad_perm:[0,0,0,0] row_mask:0xf bank_mask:0xf
    s_nop 1
    v_add_f32_dpp v29, v17, v29 quad_perm:[1,1,1,1] row_mask:0xf bank_mask:0xf
    s_nop 1
    v_add_f32_dpp v29, v18, v29 quad_perm:[2,2,2,2] row_mask:0xf bank_mask:0xf
    s_nop 1
    v_add_f32_dpp v29, v19, v29 quad_perm:[3,3,3,3] row_mask:0xf bank_mask:0xf
    v_cvt_pk_bf16_f32 v31, 0, v28
    v_cvt_pk_bf16_f32 v32, 0, v29
    v_mul_f32 v31, s50, v31
    v_mul_f32 v32, s50, v32
    v_cvt_pk_bf16_f32 v30, v31, v32
    v_max3_f32 v53, v53, v31, v32
    ds_write_b32 v54, v30 offset:512
    v_mfma_f32_16x16x32_bf16 v[12:15], v[116:119], v[8:11], v[12:15]
    s_add_u32 s45, s45, 1
    s_or_b32 s44, s45, 32
    s_ff1_i32_b32 m0, s44
    s_nop 0
    s_movrels_b32 s44, s60
    s_xor_b32 s46, s46, s44
    v_xor_b32 v52, s46, v2
    s_waitcnt vmcnt(4)
    buffer_load_dwordx4 v[80:83], v52, s[36:39], 0 offen nt
    v_mfma_f32_16x16x32_bf16 v[16:19], v[120:123], v[4:7], 0
    v_mfma_f32_16x16x32_bf16 v[16:19], v[124:127], v[8:11], v[16:19]
    v_mov_b32_dpp v28, v12 quad_perm:[0,0,0,0] row_mask:0xf bank_mask:0xf
    s_nop 1
    v_add_f32_dpp v28, v13, v28 quad_perm:[1,1,1,1] row_mask:0xf bank_mask:0xf
    s_nop 1
    v_add_f32_dpp v28, v14, v28 quad_perm:[2,2,2,2] row_mask:0xf bank_mask:0xf
    s_nop 1
    v_add_f32_dpp v28, v15, v28 quad_perm:[3,3,3,3] row_mask:0xf bank_mask:0xf
    v_mfma_f32_16x16x32_bf16 v[12:15], v[128:131], v[4:7], 0
    v_mov_b32_dpp v29, v16 quad_perm:[0,0,0,0] row_mask:0xf bank_mask:0xf
    s_nop 1
    v_add_f32_dpp v29, v17, v29 quad_perm:[1,1,1,1] row_mask:0xf bank_mask:0xf
    s_nop 1
    v_add_f32_dpp v29, v18, v29 quad_perm:[2,2,2,2] row_mask:0xf bank_mask:0xf
    s_nop 1
    v_add_f32_dpp v29, v19, v29 quad_perm:[3,3,3,3] row_mask:0xf bank_mask:0xf
    v_cvt_pk_bf16_f32 v31, 0, v28
    v_cvt_pk_bf16_f32 v32, 0, v29
    v_mul_f32 v31, s50, v31
    v_mul_f32 v32, s50, v32
    v_cvt_pk_bf16_f32 v30, v31, v32
    v_max3_f32 v53, v53, v31, v32
    ds_write_b32 v54, v30 offset:768
    s_xor_b32 s59, s46, 0x00000300
    v_xor_b32 v52, s59, v2
    s_waitcnt vmcnt(4)
    buffer_load_dwordx4 v[84:87], v52, s[36:39], 0 offen nt
    v_mfma_f32_16x16x32_bf16 v[12:15], v[132:135], v[8:11], v[12:15]
    v_mfma_f32_16x16x32_bf16 v[16:19], v[136:139], v[4:7], 0
    v_mfma_f32_16x16x32_bf16 v[16:19], v[140:143], v[8:11], v[16:19]
    s_nop 5
    v_mov_b32_dpp v28, v12 quad_perm:[0,0,0,0] row_mask:0xf bank_mask:0xf
    s_nop 1
    v_add_f32_dpp v28, v13, v28 quad_perm:[1,1,1,1] row_mask:0xf bank_mask:0xf
    s_nop 1
    v_add_f32_dpp v28, v14, v28 quad_perm:[2,2,2,2] row_mask:0xf bank_mask:0xf
    s_nop 1
    v_add_f32_dpp v28, v15, v28 quad_perm:[3,3,3,3] row_mask:0xf bank_mask:0xf
    s_xor_b32 s59, s46, 0x00018000
    v_xor_b32 v52, s59, v2
    s_waitcnt vmcnt(5)
    buffer_load_dwordx4 v[88:91], v52, s[36:39], 0 offen nt
    v_mfma_f32_16x16x32_bf16 v[12:15], v[144:147], v[4:7], 0
    v_mov_b32_dpp v29, v16 quad_perm:[0,0,0,0] row_mask:0xf bank_mask:0xf
    s_nop 1
    v_add_f32_dpp v29, v17, v29 quad_perm:[1,1,1,1] row_mask:0xf bank_mask:0xf
    s_nop 1
    v_add_f32_dpp v29, v18, v29 quad_perm:[2,2,2,2] row_mask:0xf bank_mask:0xf
    s_nop 1
    v_add_f32_dpp v29, v19, v29 quad_perm:[3,3,3,3] row_mask:0xf bank_mask:0xf
    v_cvt_pk_bf16_f32 v31, 0, v28
    v_cvt_pk_bf16_f32 v32, 0, v29
    v_mul_f32 v31, s50, v31
    v_mul_f32 v32, s50, v32
    v_cvt_pk_bf16_f32 v30, v31, v32
    v_max3_f32 v53, v53, v31, v32
    ds_write_b32 v54, v30 offset:1024
    v_mfma_f32_16x16x32_bf16 v[12:15], v[148:151], v[8:11], v[12:15]
    v_mfma_f32_16x16x32_bf16 v[16:19], v[152:155], v[4:7], 0
    s_xor_b32 s59, s46, 0x00018300
    v_xor_b32 v52, s59, v2
    s_waitcnt vmcnt(4)
    buffer_load_dwordx4 v[92:95], v52, s[36:39], 0 offen nt
    v_mfma_f32_16x16x32_bf16 v[16:19], v[156:159], v[8:11], v[16:19]
    s_nop 1
    v_mov_b32_dpp v28, v12 quad_perm:[0,0,0,0] row_mask:0xf bank_mask:0xf
    s_nop 1
    v_add_f32_dpp v28, v13, v28 quad_perm:[1,1,1,1] row_mask:0xf bank_mask:0xf
    s_nop 1
    v_add_f32_dpp v28, v14, v28 quad_perm:[2,2,2,2] row_mask:0xf bank_mask:0xf
    s_nop 1
    v_add_f32_dpp v28, v15, v28 quad_perm:[3,3,3,3] row_mask:0xf bank_mask:0xf
    v_mfma_f32_16x16x32_bf16 v[12:15], v[160:163], v[4:7], 0
    v_mov_b32_dpp v29, v16 quad_perm:[0,0,0,0] row_mask:0xf bank_mask:0xf
    s_nop 1
    v_add_f32_dpp v29, v17, v29 quad_perm:[1,1,1,1] row_mask:0xf bank_mask:0xf
    s_nop 1
    v_add_f32_dpp v29, v18, v29 quad_perm:[2,2,2,2] row_mask:0xf bank_mask:0xf
    s_nop 1
    v_add_f32_dpp v29, v19, v29 quad_perm:[3,3,3,3] row_mask:0xf bank_mask:0xf
    v_cvt_pk_bf16_f32 v31, 0, v28
    v_cvt_pk_bf16_f32 v32, 0, v29
    v_mul_f32 v31, s50, v31
    v_mul_f32 v32, s50, v32
    v_cvt_pk_bf16_f32 v30, v31, v32
    v_max3_f32 v53, v53, v31, v32
    ds_write_b32 v54, v30 offset:1280
    v_mfma_f32_16x16x32_bf16 v[12:15], v[164:167], v[8:11], v[12:15]
    s_add_u32 s45, s45, 1
    s_or_b32 s44, s45, 32
    s_ff1_i32_b32 m0, s44
    s_nop 0
    s_movrels_b32 s44, s60
    s_xor_b32 s46, s46, s44
    v_xor_b32 v52, s46, v2
    s_waitcnt vmcnt(5)
    s_cbranch_vccnz 1
    s_waitcnt vmcnt(4)
    buffer_load_dwordx4 v[96:99], v52, s[36:39], 0 offen nt
    v_mfma_f32_16x16x32_bf16 v[16:19], v[168:171], v[4:7], 0
    v_mfma_f32_16x16x32_bf16 v[16:19], v[172:175], v[8:11], v[16:19]
    v_mov_b32_dpp v28, v12 quad_perm:[0,0,0,0] row_mask:0xf bank_mask:0xf
    s_nop 1
    v_add_f32_dpp v28, v13, v28 quad_perm:[1,1,1,1] row_mask:0xf bank_mask:0xf
    s_nop 1
    v_add_f32_dpp v28, v14, v28 quad_perm:[2,2,2,2] row_mask:0xf bank_mask:0xf
    s_nop 1
    v_add_f32_dpp v28, v15, v28 quad_perm:[3,3,3,3] row_mask:0xf bank_mask:0xf
    v_mfma_f32_16x16x32_bf16 v[12:15], v[176:179], v[4:7], 0
    v_mov_b32_dpp v29, v16 quad_perm:[0,0,0,0] row_mask:0xf bank_mask:0xf
    s_nop 1
    v_add_f32_dpp v29, v17, v29 quad_perm:[1,1,1,1] row_mask:0xf bank_mask:0xf
    s_nop 1
    v_add_f32_dpp v29, v18, v29 quad_perm:[2,2,2,2] row_mask:0xf bank_mask:0xf
    s_nop 1
    v_add_f32_dpp v29, v19, v29 quad_perm:[3,3,3,3] row_mask:0xf bank_mask:0xf
    v_cvt_pk_bf16_f32 v31, 0, v28
    v_cvt_pk_bf16_f32 v32, 0, v29
    v_mul_f32 v31, s50, v31
    v_mul_f32 v32, s50, v32
    v_cvt_pk_bf16_f32 v30, v31, v32
    v_max3_f32 v53, v53, v31, v32
    ds_write_b32 v54, v30 offset:1536
    s_xor_b32 s59, s46, 0x00000300
    v_xor_b32 v52, s59, v2
    s_waitcnt vmcnt(4)
    buffer_load_dwordx4 v[100:103], v52, s[36:39], 0 offen nt
    v_mfma_f32_16x16x32_bf16 v[12:15], v[180:183], v[8:11], v[12:15]
    v_mfma_f32_16x16x32_bf16 v[16:19], v[184:187], v[4:7], 0
    v_mfma_f32_16x16x32_bf16 v[16:19], v[188:191], v[8:11], v[16:19]
    s_nop 5
    v_mov_b32_dpp v28, v12 quad_perm:[0,0,0,0] row_mask:0xf bank_mask:0xf
    s_nop 1
    v_add_f32_dpp v28, v13, v28 quad_perm:[1,1,1,1] row_mask:0xf bank_mask:0xf
    s_nop 1
    v_add_f32_dpp v28, v14, v28 quad_perm:[2,2,2,2] row_mask:0xf bank_mask:0xf
    s_nop 1
    v_add_f32_dpp v28, v15, v28 quad_perm:[3,3,3,3] row_mask:0xf bank_mask:0xf
    s_xor_b32 s59, s46, 0x00018000
    v_xor_b32 v52, s59, v2
    s_waitcnt vmcnt(5)
    buffer_load_dwordx4 v[104:107], v52, s[36:39], 0 offen nt
    v_mfma_f32_16x16x32_bf16 v[12:15], v[192:195], v[4:7], 0
    v_mov_b32_dpp v29, v16 quad_perm:[0,0,0,0] row_mask:0xf bank_mask:0xf
    s_nop 1
    v_add_f32_dpp v29, v17, v29 quad_perm:[1,1,1,1] row_mask:0xf bank_mask:0xf
    s_nop 1
    v_add_f32_dpp v29, v18, v29 quad_perm:[2,2,2,2] row_mask:0xf bank_mask:0xf
    s_nop 1
    v_add_f32_dpp v29, v19, v29 quad_perm:[3,3,3,3] row_mask:0xf bank_mask:0xf
    v_cvt_pk_bf16_f32 v31, 0, v28
    v_cvt_pk_bf16_f32 v32, 0, v29
    v_mul_f32 v31, s50, v31
    v_mul_f32 v32, s50, v32
    v_cvt_pk_bf16_f32 v30, v31, v32
    v_max3_f32 v53, v53, v31, v32
    ds_write_b32 v54, v30 offset:1792
    v_mfma_f32_16x16x32_bf16 v[12:15], v[196:199], v[8:11], v[12:15]
    v_mfma_f32_16x16x32_bf16 v[16:19], v[200:203], v[4:7], 0
    s_xor_b32 s59, s46, 0x00018300
    v_xor_b32 v52, s59, v2
    s_waitcnt vmcnt(4)
    buffer_load_dwordx4 v[108:111], v52, s[36:39], 0 offen nt
    v_mfma_f32_16x16x32_bf16 v[16:19], v[204:207], v[8:11], v[16:19]
    s_nop 1
    v_mov_b32_dpp v28, v12 quad_perm:[0,0,0,0] row_mask:0xf bank_mask:0xf
    s_nop 1
    v_add_f32_dpp v28, v13, v28 quad_perm:[1,1,1,1] row_mask:0xf bank_mask:0xf
    s_nop 1
    v_add_f32_dpp v28, v14, v28 quad_perm:[2,2,2,2] row_mask:0xf bank_mask:0xf
    s_nop 1
    v_add_f32_dpp v28, v15, v28 quad_perm:[3,3,3,3] row_mask:0xf bank_mask:0xf
    v_mfma_f32_16x16x32_bf16 v[12:15], v[208:211], v[4:7], 0
    v_mov_b32_dpp v29, v16 quad_perm:[0,0,0,0] row_mask:0xf bank_mask:0xf
    s_nop 1
    v_add_f32_dpp v29, v17, v29 quad_perm:[1,1,1,1] row_mask:0xf bank_mask:0xf
    s_nop 1
    v_add_f32_dpp v29, v18, v29 quad_perm:[2,2,2,2] row_mask:0xf bank_mask:0xf
    s_nop 1
    v_add_f32_dpp v29, v19, v29 quad_perm:[3,3,3,3] row_mask:0xf bank_mask:0xf
    v_cvt_pk_bf16_f32 v31, 0, v28
    v_cvt_pk_bf16_f32 v32, 0, v29
    v_mul_f32 v31, s50, v31
    v_mul_f32 v32, s50, v32
    v_cvt_pk_bf16_f32 v30, v31, v32
    v_max3_f32 v53, v53, v31, v32
    ds_write_b32 v54, v30 offset:2048
    v_mfma_f32_16x16x32_bf16 v[12:15], v[212:215], v[8:11], v[12:15]
    s_add_u32 s45, s45, 1
    s_or_b32 s44, s45, 32
    s_ff1_i32_b32 m0, s44
    s_nop 0
    s_movrels_b32 s44, s60
    s_xor_b32 s46, s46, s44
    v_xor_b32 v52, s46, v2
    s_waitcnt vmcnt(4)
    buffer_load_dwordx4 v[112:115], v52, s[36:39], 0 offen nt
    v_mfma_f32_16x16x32_bf16 v[16:19], v[216:219], v[4:7], 0
    v_mfma_f32_16x16x32_bf16 v[16:19], v[220:223], v[8:11], v[16:19]
    v_mov_b32_dpp v28, v12 quad_perm:[0,0,0,0] row_mask:0xf bank_mask:0xf
    s_nop 1
    v_add_f32_dpp v28, v13, v28 quad_perm:[1,1,1,1] row_mask:0xf bank_mask:0xf
    s_nop 1
    v_add_f32_dpp v28, v14, v28 quad_perm:[2,2,2,2] row_mask:0xf bank_mask:0xf
    s_nop 1
    v_add_f32_dpp v28, v15, v28 quad_perm:[3,3,3,3] row_mask:0xf bank_mask:0xf
    v_mfma_f32_16x16x32_bf16 v[12:15], v[224:227], v[4:7], 0
    v_mov_b32_dpp v29, v16 quad_perm:[0,0,0,0] row_mask:0xf bank_mask:0xf
    s_nop 1
    v_add_f32_dpp v29, v17, v29 quad_perm:[1,1,1,1] row_mask:0xf bank_mask:0xf
    s_nop 1
    v_add_f32_dpp v29, v18, v29 quad_perm:[2,2,2,2] row_mask:0xf bank_mask:0xf
    s_nop 1
    v_add_f32_dpp v29, v19, v29 quad_perm:[3,3,3,3] row_mask:0xf bank_mask:0xf
    v_cvt_pk_bf16_f32 v31, 0, v28
    v_cvt_pk_bf16_f32 v32, 0, v29
    v_mul_f32 v31, s50, v31
    v_mul_f32 v32, s50, v32
    v_cvt_pk_bf16_f32 v30, v31, v32
    v_max3_f32 v53, v53, v31, v32
    ds_write_b32 v54, v30 offset:2304
    s_xor_b32 s59, s46, 0x00000300
    v_xor_b32 v52, s59, v2
    s_waitcnt vmcnt(4)
    buffer_load_dwordx4 v[116:119], v52, s[36:39], 0 offen nt
    v_mfma_f32_16x16x32_bf16 v[12:15], v[228:231], v[8:11], v[12:15]
    v_mfma_f32_16x16x32_bf16 v[16:19], v[232:235], v[4:7], 0
    v_mfma_f32_16x16x32_bf16 v[16:19], v[236:239], v[8:11], v[16:19]
    s_nop 5
    v_mov_b32_dpp v28, v12 quad_perm:[0,0,0,0] row_mask:0xf bank_mask:0xf
    s_nop 1
    v_add_f32_dpp v28, v13, v28 quad_perm:[1,1,1,1] row_mask:0xf bank_mask:0xf
    s_nop 1
    v_add_f32_dpp v28, v14, v28 quad_perm:[2,2,2,2] row_mask:0xf bank_mask:0xf
    s_nop 1
    v_add_f32_dpp v28, v15, v28 quad_perm:[3,3,3,3] row_mask:0xf bank_mask:0xf
    s_xor_b32 s59, s46, 0x00018000
    v_xor_b32 v52, s59, v2
    s_waitcnt vmcnt(5)
    buffer_load_dwordx4 v[120:123], v52, s[36:39], 0 offen nt
    v_mfma_f32_16x16x32_bf16 v[12:15], v[240:243], v[4:7], 0
    v_mov_b32_dpp v29, v16 quad_perm:[0,0,0,0] row_mask:0xf bank_mask:0xf
    s_nop 1
    v_add_f32_dpp v29, v17, v29 quad_perm:[1,1,1,1] row_mask:0xf bank_mask:0xf
    s_nop 1
    v_add_f32_dpp v29, v18, v29 quad_perm:[2,2,2,2] row_mask:0xf bank_mask:0xf
    s_nop 1
    v_add_f32_dpp v29, v19, v29 quad_perm:[3,3,3,3] row_mask:0xf bank_mask:0xf
    v_cvt_pk_bf16_f32 v31, 0, v28
    v_cvt_pk_bf16_f32 v32, 0, v29
    v_mul_f32 v31, s50, v31
    v_mul_f32 v32, s50, v32
    v_cvt_pk_bf16_f32 v30, v31, v32
    v_max3_f32 v53, v53, v31, v32
    ds_write_b32 v54, v30 offset:2560
    v_mfma_f32_16x16x32_bf16 v[12:15], v[244:247], v[8:11], v[12:15]
    v_mfma_f32_16x16x32_bf16 v[16:19], v[248:251], v[4:7], 0
    s_xor_b32 s59, s46, 0x00018300
    v_xor_b32 v52, s59, v2
    s_waitcnt vmcnt(4)
    buffer_load_dwordx4 v[124:127], v52, s[36:39], 0 offen nt
    v_mfma_f32_16x16x32_bf16 v[16:19], v[252:255], v[8:11], v[16:19]
    s_nop 1
    v_mov_b32_dpp v28, v12 quad_perm:[0,0,0,0] row_mask:0xf bank_mask:0xf
    s_nop 1
    v_add_f32_dpp v28, v13, v28 quad_perm:[1,1,1,1] row_mask:0xf bank_mask:0xf
    s_nop 1
    v_add_f32_dpp v28, v14, v28 quad_perm:[2,2,2,2] row_mask:0xf bank_mask:0xf
    s_nop 1
    v_add_f32_dpp v28, v15, v28 quad_perm:[3,3,3,3] row_mask:0xf bank_mask:0xf
    v_mfma_f32_16x16x32_bf16 v[12:15], v[64:67], v[4:7], 0
    v_mov_b32_dpp v29, v16 quad_perm:[0,0,0,0] row_mask:0xf bank_mask:0xf
    s_nop 1
    v_add_f32_dpp v29, v17, v29 quad_perm:[1,1,1,1] row_mask:0xf bank_mask:0xf
    s_nop 1
    v_add_f32_dpp v29, v18, v29 quad_perm:[2,2,2,2] row_mask:0xf bank_mask:0xf
    s_nop 1
    v_add_f32_dpp v29, v19, v29 quad_perm:[3,3,3,3] row_mask:0xf bank_mask:0xf
    v_cvt_pk_bf16_f32 v31, 0, v28
    v_cvt_pk_bf16_f32 v32, 0, v29
    v_mul_f32 v31, s50, v31
    v_mul_f32 v32, s50, v32
    v_cvt_pk_bf16_f32 v30, v31, v32
    v_max3_f32 v53, v53, v31, v32
    ds_write_b32 v54, v30 offset:2816
    v_mfma_f32_16x16x32_bf16 v[12:15], v[68:71], v[8:11], v[12:15]
    s_add_u32 s45, s45, 1
    s_or_b32 s44, s45, 32
    s_ff1_i32_b32 m0, s44
    s_nop 0
    s_movrels_b32 s44, s60
    s_xor_b32 s46, s46, s44
    v_xor_b32 v52, s46, v2
    s_waitcnt vmcnt(4)
    buffer_load_dwordx4 v[64:67], v52, s[36:39], 0 offen nt
    v_mfma_f32_16x16x32_bf16 v[16:19], v[72:75], v[4:7], 0
    v_mfma_f32_16x16x32_bf16 v[16:19], v[76:79], v[8:11], v[16:19]
    v_mov_b32_dpp v28, v12 quad_perm:[0,0,0,0] row_mask:0xf bank_mask:0xf
    s_nop 1
    v_add_f32_dpp v28, v13, v28 quad_perm:[1,1,1,1] row_mask:0xf bank_mask:0xf
    s_nop 1
    v_add_f32_dpp v28, v14, v28 quad_perm:[2,2,2,2] row_mask:0xf bank_mask:0xf
    s_nop 1
    v_add_f32_dpp v28, v15, v28 quad_perm:[3,3,3,3] row_mask:0xf bank_mask:0xf
    v_mfma_f32_16x16x32_bf16 v[12:15], v[80:83], v[4:7], 0
    v_mov_b32_dpp v29, v16 quad_perm:[0,0,0,0] row_mask:0xf bank_mask:0xf
    s_nop 1
    v_add_f32_dpp v29, v17, v29 quad_perm:[1,1,1,1] row_mask:0xf bank_mask:0xf
    s_nop 1
    v_add_f32_dpp v29, v18, v29 quad_perm:[2,2,2,2] row_mask:0xf bank_mask:0xf
    s_nop 1
    v_add_f32_dpp v29, v19, v29 quad_perm:[3,3,3,3] row_mask:0xf bank_mask:0xf
    v_cvt_pk_bf16_f32 v31, 0, v28
    v_cvt_pk_bf16_f32 v32, 0, v29
    v_mul_f32 v31, s50, v31
    v_mul_f32 v32, s50, v32
    v_cvt_pk_bf16_f32 v30, v31, v32
    v_max3_f32 v53, v53, v31, v32
    ds_write_b32 v54, v30 offset:3072
    s_xor_b32 s59, s46, 0x00000300
    v_xor_b32 v52, s59, v2
    s_waitcnt vmcnt(4)
    buffer_load_dwordx4 v[68:71], v52, s[36:39], 0 offen nt
    v_mfma_f32_16x16x32_bf16 v[12:15], v[84:87], v[8:11], v[12:15]
    v_mfma_f32_16x16x32_bf16 v[16:19], v[88:91], v[4:7], 0
    v_mfma_f32_16x16x32_bf16 v[16:19], v[92:95], v[8:11], v[16:19]
    s_nop 5
    v_mov_b32_dpp v28, v12 quad_perm:[0,0,0,0] row_mask:0xf bank_mask:0xf
    s_nop 1
    v_add_f32_dpp v28, v13, v28 quad_perm:[1,1,1,1] row_mask:0xf bank_mask:0xf
    s_nop 1
    v_add_f32_dpp v28, v14, v28 quad_perm:[2,2,2,2] row_mask:0xf bank_mask:0xf
    s_nop 1
    v_add_f32_dpp v28, v15, v28 quad_perm:[3,3,3,3] row_mask:0xf bank_mask:0xf
    s_xor_b32 s59, s46, 0x00018000
    v_xor_b32 v52, s59, v2
    s_waitcnt vmcnt(5)
    s_cbranch_vccnz 1
    s_waitcnt vmcnt(4)
    buffer_load_dwordx4 v[72:75], v52, s[36:39], 0 offen nt
    v_mfma_f32_16x16x32_bf16 v[12:15], v[96:99], v[4:7], 0
    v_mov_b32_dpp v29, v16 quad_perm:[0,0,0,0] row_mask:0xf bank_mask:0xf
    s_nop 1
    v_add_f32_dpp v29, v17, v29 quad_perm:[1,1,1,1] row_mask:0xf bank_mask:0xf
    s_nop 1
    v_add_f32_dpp v29, v18, v29 quad_perm:[2,2,2,2] row_mask:0xf bank_mask:0xf
    s_nop 1
    v_add_f32_dpp v29, v19, v29 quad_perm:[3,3,3,3] row_mask:0xf bank_mask:0xf
    v_cvt_pk_bf16_f32 v31, 0, v28
    v_cvt_pk_bf16_f32 v32, 0, v29
    v_mul_f32 v31, s50, v31
    v_mul_f32 v32, s50, v32
    v_cvt_pk_bf16_f32 v30, v31, v32
    v_max3_f32 v53, v53, v31, v32
    ds_write_b32 v54, v30 offset:3328
    v_mfma_f32_16x16x32_bf16 v[12:15], v[100:103], v[8:11], v[12:15]
    v_mfma_f32_16x16x32_bf16 v[16:19], v[104:107], v[4:7], 0
    s_xor_b32 s59, s46, 0x00018300
    v_xor_b32 v52, s59, v2
    s_waitcnt vmcnt(4)
    buffer_load_dwordx4 v[76:79], v52, s[36:39], 0 offen nt
    v_mfma_f32_16x16x32_bf16 v[16:19], v[108:111], v[8:11], v[16:19]
    s_nop 1
    v_mov_b32_dpp v28, v12 quad_perm:[0,0,0,0] row_mask:0xf bank_mask:0xf
    s_nop 1
    v_add_f32_dpp v28, v13, v28 quad_perm:[1,1,1,1] row_mask:0xf bank_mask:0xf
    s_nop 1
    v_add_f32_dpp v28, v14, v28 quad_perm:[2,2,2,2] row_mask:0xf bank_mask:0xf
    s_nop 1
    v_add_f32_dpp v28, v15, v28 quad_perm:[3,3,3,3] row_mask:0xf bank_mask:0xf
    v_mfma_f32_16x16x32_bf16 v[12:15], v[112:115], v[4:7], 0
    v_mov_b32_dpp v29, v16 quad_perm:[0,0,0,0] row_mask:0xf bank_mask:0xf
    s_nop 1
    v_add_f32_dpp v29, v17, v29 quad_perm:[1,1,1,1] row_mask:0xf bank_mask:0xf
    s_nop 1
    v_add_f32_dpp v29, v18, v29 quad_perm:[2,2,2,2] row_mask:0xf bank_mask:0xf
    s_nop 1
    v_add_f32_dpp v29, v19, v29 quad_perm:[3,3,3,3] row_mask:0xf bank_mask:0xf
    v_cvt_pk_bf16_f32 v31, 0, v28
    v_cvt_pk_bf16_f32 v32, 0, v29
    v_mul_f32 v31, s50, v31
    v_mul_f32 v32, s50, v32
    v_cvt_pk_bf16_f32 v30, v31, v32
    v_max3_f32 v53, v53, v31, v32
    ds_write_b32 v54, v30 offset:3584
    v_mfma_f32_16x16x32_bf16 v[12:15], v[116:119], v[8:11], v[12:15]
    s_add_u32 s45, s45, 1
    s_or_b32 s44, s45, 32
    s_ff1_i32_b32 m0, s44
    s_nop 0
    s_movrels_b32 s44, s60
    s_xor_b32 s46, s46, s44
    v_xor_b32 v52, s46, v2
    s_waitcnt vmcnt(4)
    buffer_load_dwordx4 v[80:83], v52, s[36:39], 0 offen nt
    v_mfma_f32_16x16x32_bf16 v[16:19], v[120:123], v[4:7], 0
    s_xor_b32 s59, s46, 0x00000300
    v_xor_b32 v52, s59, v2
    s_waitcnt vmcnt(4)
    buffer_load_dwordx4 v[84:87], v52, s[36:39], 0 offen nt
    v_mfma_f32_16x16x32_bf16 v[16:19], v[124:127], v[8:11], v[16:19]
    v_mov_b32_dpp v28, v12 quad_perm:[0,0,0,0] row_mask:0xf bank_mask:0xf
    s_nop 1
    v_add_f32_dpp v28, v13, v28 quad_perm:[1,1,1,1] row_mask:0xf bank_mask:0xf
    s_nop 1
    v_add_f32_dpp v28, v14, v28 quad_perm:[2,2,2,2] row_mask:0xf bank_mask:0xf
    s_nop 1
    v_add_f32_dpp v28, v15, v28 quad_perm:[3,3,3,3] row_mask:0xf bank_mask:0xf
    v_add_u32 v54, 3840, v54
    s_mov_b32 s53, 11
L_kloop:
    s_nop 7
    s_xor_b32 s59, s46, 0x00018000
    v_xor_b32 v52, s59, v2
    s_waitcnt vmcnt(5)
    buffer_load_dwordx4 v[88:91], v52, s[36:39], 0 offen nt
    v_mfma_f32_16x16x32_bf16 v[12:15], v[64:67], v[4:7], 0
    v_mov_b32_dpp v29, v16 quad_perm:[0,0,0,0] row_mask:0xf bank_mask:0xf
    s_nop 1
    v_add_f32_dpp v29, v17, v29 quad_perm:[1,1,1,1] row_mask:0xf bank_mask:0xf
    s_nop 1
    v_add_f32_dpp v29, v18, v29 quad_perm:[2,2,2,2] row_mask:0xf bank_mask:0xf
    s_nop 1
    v_add_f32_dpp v29, v19, v29 quad_perm:[3,3,3,3] row_mask:0xf bank_mask:0xf
    v_cvt_pk_bf16_f32 v31, 0, v28
    v_cvt_pk_bf16_f32 v32, 0, v29
    v_mul_f32 v31, s50, v31
    v_mul_f32 v32, s50, v32
    v_cvt_pk_bf16_f32 v30, v31, v32
    v_max3_f32 v53, v53, v31, v32
    ds_write_b32 v54, v30 offset:0
    s_xor_b32 s59, s46, 0x00018300
    v_xor_b32 v52, s59, v2
    s_waitcnt vmcnt(4)
    buffer_load_dwordx4 v[92:95], v52, s[36:39], 0 offen nt
    v_mfma_f32_16x16x32_bf16 v[12:15], v[68:71], v[8:11], v[12:15]
    s_add_u32 s45, s45, 1
    s_or_b32 s44, s45, 32
    s_ff1_i32_b32 m0, s44
    s_nop 0
    s_movrels_b32 s44, s60
    s_xor_b32 s46, s46, s44
    v_xor_b32 v52, s46, v2
    s_waitcnt vmcnt(5)
    s_cbranch_vccnz 1
    s_waitcnt vmcnt(4)
    buffer_load_dwordx4 v[96:99], v52, s[36:39], 0 offen nt
    v_mfma_f32_16x16x32_bf16 v[16:19], v[72:75], v[4:7], 0
    s_xor_b32 s59, s46, 0x00000300
    v_xor_b32 v52, s59, v2
    s_waitcnt vmcnt(4)
    buffer_load_dwordx4 v[100:103], v52, s[36:39], 0 offen nt
    v_mfma_f32_16x16x32_bf16 v[16:19], v[76:79], v[8:11], v[16:19]
    v_mov_b32_dpp v28, v12 quad_perm:[0,0,0,0] row_mask:0xf bank_mask:0xf
    s_nop 1
    v_add_f32_dpp v28, v13, v28 quad_perm:[1,1,1,1] row_mask:0xf bank_mask:0xf
    s_nop 1
    v_add_f32_dpp v28, v14, v28 quad_perm:[2,2,2,2] row_mask:0xf bank_mask:0xf
    s_nop 1
    v_add_f32_dpp v28, v15, v28 quad_perm:[3,3,3,3] row_mask:0xf bank_mask:0xf
    s_xor_b32 s59, s46, 0x00018000
    v_xor_b32 v52, s59, v2
    s_waitcnt vmcnt(5)
    buffer_load_dwordx4 v[104:107], v52, s[36:39], 0 offen nt
    v_mfma_f32_16x16x32_bf16 v[12:15], v[80:83], v[4:7], 0
    v_mov_b32_dpp v29, v16 quad_perm:[0,0,0,0] row_mask:0xf bank_mask:0xf
    s_nop 1
    v_add_f32_dpp v29, v17, v29 quad_perm:[1,1,1,1] row_mask:0xf bank_mask:0xf
    s_nop 1
    v_add_f32_dpp v29, v18, v29 quad_perm:[2,2,2,2] row_mask:0xf bank_mask:0xf
    s_nop 1
    v_add_f32_dpp v29, v19, v29 quad_perm:[3,3,3,3] row_mask:0xf bank_mask:0xf
    v_cvt_pk_bf16_f32 v31, 0, v28
    v_cvt_pk_bf16_f32 v32, 0, v29
    v_mul_f32 v31, s50, v31
    v_mul_f32 v32, s50, v32
    v_cvt_pk_bf16_f32 v30, v31, v32
    v_max3_f32 v53, v53, v31, v32
    ds_write_b32 v54, v30 offset:256
    s_xor_b32 s59, s46, 0x00018300
    v_xor_b32 v52, s59, v2
    s_waitcnt vmcnt(4)
    buffer_load_dwordx4 v[108:111], v52, s[36:39], 0 offen nt
    v_mfma_f32_16x16x32_bf16 v[12:15], v[84:87], v[8:11], v[12:15]
    s_add_u32 s45, s45, 1
    s_or_b32 s44, s45, 32
    s_ff1_i32_b32 m0, s44
    s_nop 0
    s_movrels_b32 s44, s60
    s_xor_b32 s46, s46, s44
    v_xor_b32 v52, s46, v2
    s_waitcnt vmcnt(4)
    buffer_load_dwordx4 v[112:115], v52, s[36:39], 0 offen nt
    v_mfma_f32_16x16x32_bf16 v[16:19], v[88:91], v[4:7], 0
    s_xor_b32 s59, s46, 0x00000300
    v_xor_b32 v52, s59, v2
    s_waitcnt vmcnt(4)
    buffer_load_dwordx4 v[116:119], v52, s[36:39], 0 offen nt
    v_mfma_f32_16x16x32_bf16 v[16:19], v[92:95], v[8:11], v[16:19]
    v_mov_b32_dpp v28, v12 quad_perm:[0,0,0,0] row_mask:0xf bank_mask:0xf
    s_nop 1
    v_add_f32_dpp v28, v13, v28 quad_perm:[1,1,1,1] row_mask:0xf bank_mask:0xf
    s_nop 1
    v_add_f32_dpp v28, v14, v28 quad_perm:[2,2,2,2] row_mask:0xf bank_mask:0xf
    s_nop 1
    v_add_f32_dpp v28, v15, v28 quad_perm:[3,3,3,3] row_mask:0xf bank_mask:0xf
    s_xor_b32 s59, s46, 0x00018000
    v_xor_b32 v52, s59, v2
    s_waitcnt vmcnt(5)
    buffer_load_dwordx4 v[120:123], v52, s[36:39], 0 offen nt
    v_mfma_f32_16x16x32_bf16 v[12:15], v[96:99], v[4:7], 0
    v_mov_b32_dpp v29, v16 quad_perm:[0,0,0,0] row_mask:0xf bank_mask:0xf
    s_nop 1
    v_add_f32_dpp v29, v17, v29 quad_perm:[1,1,1,1] row_mask:0xf bank_mask:0xf
    s_nop 1
    v_add_f32_dpp v29, v18, v29 quad_perm:[2,2,2,2] row_mask:0xf bank_mask:0xf
    s_nop 1
    v_add_f32_dpp v29, v19, v29 quad_perm:[3,3,3,3] row_mask:0xf bank_mask:0xf
    v_cvt_pk_bf16_f32 v31, 0, v28
    v_cvt_pk_bf16_f32 v32, 0, v29
    v_mul_f32 v31, s50, v31
    v_mul_f32 v32, s50, v32
    v_cvt_pk_bf16_f32 v30, v31, v32
    v_max3_f32 v53, v53, v31, v32
    ds_write_b32 v54, v30 offset:512
    s_xor_b32 s59, s46, 0x00018300
    v_xor_b32 v52, s59, v2
    s_waitcnt vmcnt(4)
    buffer_load_dwordx4 v[124:127], v52, s[36:39], 0 offen nt
    v_mfma_f32_16x16x32_bf16 v[12:15], v[100:103], v[8:11], v[12:15]
    s_add_u32 s45, s45, 1
    s_or_b32 s44, s45, 32
    s_ff1_i32_b32 m0, s44
    s_nop 0
    s_movrels_b32 s44, s60
    s_xor_b32 s46, s46, s44
    v_xor_b32 v52, s46, v2
    s_waitcnt vmcnt(4)
    buffer_load_dwordx4 v[64:67], v52, s[36:39], 0 offen nt
    v_mfma_f32_16x16x32_bf16 v[16:19], v[104:107], v[4:7], 0
    s_xor_b32 s59, s46, 0x00000300
    v_xor_b32 v52, s59, v2
    s_waitcnt vmcnt(4)
    buffer_load_dwordx4 v[68:71], v52, s[36:39], 0 offen nt
    v_mfma_f32_16x16x32_bf16 v[16:19], v[108:111], v[8:11], v[16:19]
    v_mov_b32_dpp v28, v12 quad_perm:[0,0,0,0] row_mask:0xf bank_mask:0xf
    s_nop 1
    v_add_f32_dpp v28, v13, v28 quad_perm:[1,1,1,1] row_mask:0xf bank_mask:0xf
    s_nop 1
    v_add_f32_dpp v28, v14, v28 quad_perm:[2,2,2,2] row_mask:0xf bank_mask:0xf
    s_nop 1
    v_add_f32_dpp v28, v15, v28 quad_perm:[3,3,3,3] row_mask:0xf bank_mask:0xf
    s_xor_b32 s59, s46, 0x00018000
    v_xor_b32 v52, s59, v2
    s_waitcnt vmcnt(5)
    s_cbranch_vccnz 1
    s_waitcnt vmcnt(4)
    buffer_load_dwordx4 v[72:75], v52, s[36:39], 0 offen nt
    v_mfma_f32_16x16x32_bf16 v[12:15], v[112:115], v[4:7], 0
    v_mov_b32_dpp v29, v16 quad_perm:[0,0,0,0] row_mask:0xf bank_mask:0xf
    s_nop 1
    v_add_f32_dpp v29, v17, v29 quad_perm:[1,1,1,1] row_mask:0xf bank_mask:0xf
    s_nop 1
    v_add_f32_dpp v29, v18, v29 quad_perm:[2,2,2,2] row_mask:0xf bank_mask:0xf
    s_nop 1
    v_add_f32_dpp v29, v19, v29 quad_perm:[3,3,3,3] row_mask:0xf bank_mask:0xf
    v_cvt_pk_bf16_f32 v31, 0, v28
    v_cvt_pk_bf16_f32 v32, 0, v29
    v_mul_f32 v31, s50, v31
    v_mul_f32 v32, s50, v32
    v_cvt_pk_bf16_f32 v30, v31, v32
    v_max3_f32 v53, v53, v31, v32
    ds_write_b32 v54, v30 offset:768
    s_xor_b32 s59, s46, 0x00018300
    v_xor_b32 v52, s59, v2
    s_waitcnt vmcnt(4)
    buffer_load_dwordx4 v[76:79], v52, s[36:39], 0 offen nt
    v_mfma_f32_16x16x32_bf16 v[12:15], v[116:119], v[8:11], v[12:15]
    s_add_u32 s45, s45, 1
    s_or_b32 s44, s45, 32
    s_ff1_i32_b32 m0, s44
    s_nop 0
    s_movrels_b32 s44, s60
    s_xor_b32 s46, s46, s44
    v_xor_b32 v52, s46, v2
    s_waitcnt vmcnt(4)
    buffer_load_dwordx4 v[80:83], v52, s[36:39], 0 offen nt
    v_mfma_f32_16x16x32_bf16 v[16:19], v[120:123], v[4:7], 0
    s_xor_b32 s59, s46, 0x00000300
    v_xor_b32 v52, s59, v2
    s_waitcnt vmcnt(4)
    buffer_load_dwordx4 v[84:87], v52, s[36:39], 0 offen nt
    v_mfma_f32_16x16x32_bf16 v[16:19], v[124:127], v[8:11], v[16:19]
    v_mov_b32_dpp v28, v12 quad_perm:[0,0,0,0] row_mask:0xf bank_mask:0xf
    s_nop 1
    v_add_f32_dpp v28, v13, v28 quad_perm:[1,1,1,1] row_mask:0xf bank_mask:0xf
    s_nop 1
    v_add_f32_dpp v28, v14, v28 quad_perm:[2,2,2,2] row_mask:0xf bank_mask:0xf
    s_nop 1
    v_add_f32_dpp v28, v15, v28 quad_perm:[3,3,3,3] row_mask:0xf bank_mask:0xf
    v_add_u32 v54, 1024, v54
    s_sub_u32 s53, s53, 1
    s_cmp_lg_u32 s53, 0
    s_cbranch_scc1 L_kloop
    s_xor_b32 s59, s46, 0x00018000
    v_xor_b32 v52, s59, v2
    s_waitcnt vmcnt(5)
    buffer_load_dwordx4 v[88:91], v52, s[36:39], 0 offen nt
    v_mfma_f32_16x16x32_bf16 v[12:15], v[64:67], v[4:7], 0
    v_mov_b32_dpp v29, v16 quad_perm:[0,0,0,0] row_mask:0xf bank_mask:0xf
    s_nop 1
    v_add_f32_dpp v29, v17, v29 quad_perm:[1,1,1,1] row_mask:0xf bank_mask:0xf
    s_nop 1
    v_add_f32_dpp v29, v18, v29 quad_perm:[2,2,2,2] row_mask:0xf bank_mask:0xf
    s_nop 1
    v_add_f32_dpp v29, v19, v29 quad_perm:[3,3,3,3] row_mask:0xf bank_mask:0xf
    v_cvt_pk_bf16_f32 v31, 0, v28
    v_cvt_pk_bf16_f32 v32, 0, v29
    v_mul_f32 v31, s50, v31
    v_mul_f32 v32, s50, v32
    v_cvt_pk_bf16_f32 v30, v31, v32
    v_max3_f32 v53, v53, v31, v32
    ds_write_b32 v54, v30 offset:0
    s_xor_b32 s59, s46, 0x00018300
    v_xor_b32 v52, s59, v2
    s_waitcnt vmcnt(4)
    buffer_load_dwordx4 v[92:95], v52, s[36:39], 0 offen nt
    v_mfma_f32_16x16x32_bf16 v[12:15], v[68:71], v[8:11], v[12:15]
    s_add_u32 s45, s45, 1
    s_or_b32 s44, s45, 32
    s_ff1_i32_b32 m0, s44
    s_nop 0
    s_movrels_b32 s44, s60
    s_xor_b32 s46, s46, s44
    v_xor_b32 v52, s46, v2
    s_waitcnt vmcnt(5)
    s_cbranch_vccnz 1
    s_waitcnt vmcnt(4)
    buffer_load_dwordx4 v[96:99], v52, s[36:39], 0 offen nt
    v_mfma_f32_16x16x32_bf16 v[16:19], v[72:75], v[4:7], 0
    s_xor_b32 s59, s46, 0x00000300
    v_xor_b32 v52, s59, v2
    s_waitcnt vmcnt(4)
    buffer_load_dwordx4 v[100:103], v52, s[36:39], 0 offen nt
    v_mfma_f32_16x16x32_bf16 v[16:19], v[76:79], v[8:11], v[16:19]
    v_mov_b32_dpp v28, v12 quad_perm:[0,0,0,0] row_mask:0xf bank_mask:0xf
    s_nop 1
    v_add_f32_dpp v28, v13, v28 quad_perm:[1,1,1,1] row_mask:0xf bank_mask:0xf
    s_nop 1
    v_add_f32_dpp v28, v14, v28 quad_perm:[2,2,2,2] row_mask:0xf bank_mask:0xf
    s_nop 1
    v_add_f32_dpp v28, v15, v28 quad_perm:[3,3,3,3] row_mask:0xf bank_mask:0xf
    s_xor_b32 s59, s46, 0x00018000
    v_xor_b32 v52, s59, v2
    s_waitcnt vmcnt(5)
    buffer_load_dwordx4 v[104:107], v52, s[36:39], 0 offen nt
    v_mfma_f32_16x16x32_bf16 v[12:15], v[80:83], v[4:7], 0
    v_mov_b32_dpp v29, v16 quad_perm:[0,0,0,0] row_mask:0xf bank_mask:0xf
    s_nop 1
    v_add_f32_dpp v29, v17, v29 quad_perm:[1,1,1,1] row_mask:0xf bank_mask:0xf
    s_nop 1
    v_add_f32_dpp v29, v18, v29 quad_perm:[2,2,2,2] row_mask:0xf bank_mask:0xf
    s_nop 1
    v_add_f32_dpp v29, v19, v29 quad_perm:[3,3,3,3] row_mask:0xf bank_mask:0xf
    v_cvt_pk_bf16_f32 v31, 0, v28
    v_cvt_pk_bf16_f32 v32, 0, v29
    v_mul_f32 v31, s50, v31
    v_mul_f32 v32, s50, v32
    v_cvt_pk_bf16_f32 v30, v31, v32
    v_max3_f32 v53, v53, v31, v32
    ds_write_b32 v54, v30 offset:256
    s_xor_b32 s59, s46, 0x00018300
    v_xor_b32 v52, s59, v2
    s_waitcnt vmcnt(4)
    buffer_load_dwordx4 v[108:111], v52, s[36:39], 0 offen nt
    v_mfma_f32_16x16x32_bf16 v[12:15], v[84:87], v[8:11], v[12:15]
    s_add_u32 s45, s45, 1
    s_or_b32 s44, s45, 32
    s_ff1_i32_b32 m0, s44
    s_nop 0
    s_movrels_b32 s44, s60
    s_xor_b32 s46, s46, s44
    v_xor_b32 v52, s46, v2
    s_waitcnt vmcnt(4)
    buffer_load_dwordx4 v[112:115], v52, s[36:39], 0 offen nt
    v_mfma_f32_16x16x32_bf16 v[16:19], v[88:91], v[4:7], 0
    s_xor_b32 s59, s46, 0x00000300
    v_xor_b32 v52, s59, v2
    s_waitcnt vmcnt(4)
    buffer_load_dwordx4 v[116:119], v52, s[36:39], 0 offen nt
    v_mfma_f32_16x16x32_bf16 v[16:19], v[92:95], v[8:11], v[16:19]
    v_mov_b32_dpp v28, v12 quad_perm:[0,0,0,0] row_mask:0xf bank_mask:0xf
    s_nop 1
    v_add_f32_dpp v28, v13, v28 quad_perm:[1,1,1,1] row_mask:0xf bank_mask:0xf
    s_nop 1
    v_add_f32_dpp v28, v14, v28 quad_perm:[2,2,2,2] row_mask:0xf bank_mask:0xf
    s_nop 1
    v_add_f32_dpp v28, v15, v28 quad_perm:[3,3,3,3] row_mask:0xf bank_mask:0xf
    s_xor_b32 s59, s46, 0x00018000
    v_xor_b32 v52, s59, v2
    s_waitcnt vmcnt(5)
    buffer_load_dwordx4 v[120:123], v52, s[36:39], 0 offen nt
    v_mfma_f32_16x16x32_bf16 v[12:15], v[96:99], v[4:7], 0
    v_mov_b32_dpp v29, v16 quad_perm:[0,0,0,0] row_mask:0xf bank_mask:0xf
    s_nop 1
    v_add_f32_dpp v29, v17, v29 quad_perm:[1,1,1,1] row_mask:0xf bank_mask:0xf
    s_nop 1
    v_add_f32_dpp v29, v18, v29 quad_perm:[2,2,2,2] row_mask:0xf bank_mask:0xf
    s_nop 1
    v_add_f32_dpp v29, v19, v29 quad_perm:[3,3,3,3] row_mask:0xf bank_mask:0xf
    v_cvt_pk_bf16_f32 v31, 0, v28
    v_cvt_pk_bf16_f32 v32, 0, v29
    v_mul_f32 v31, s50, v31
    v_mul_f32 v32, s50, v32
    v_cvt_pk_bf16_f32 v30, v31, v32
    v_max3_f32 v53, v53, v31, v32
    ds_write_b32 v54, v30 offset:512
    s_xor_b32 s59, s46, 0x00018300
    v_xor_b32 v52, s59, v2
    s_waitcnt vmcnt(4)
    buffer_load_dwordx4 v[124:127], v52, s[36:39], 0 offen nt
    v_mfma_f32_16x16x32_bf16 v[12:15], v[100:103], v[8:11], v[12:15]
    s_add_u32 s45, s45, 1
    s_or_b32 s44, s45, 32
    s_ff1_i32_b32 m0, s44
    s_nop 0
    s_movrels_b32 s44, s60
    s_xor_b32 s46, s46, s44
    v_xor_b32 v52, s46, v35
    s_waitcnt vmcnt(4)
    buffer_load_dwordx4 v[64:67], v52, s[40:43], 0 offen nt
    v_mfma_f32_16x16x32_bf16 v[16:19], v[104:107], v[4:7], 0
    s_xor_b32 s59, s46, 0x00000300
    v_xor_b32 v52, s59, v35
    s_waitcnt vmcnt(4)
    buffer_load_dwordx4 v[68:71], v52, s[40:43], 0 offen nt
    v_mfma_f32_16x16x32_bf16 v[16:19], v[108:111], v[8:11], v[16:19]
    v_mov_b32_dpp v28, v12 quad_perm:[0,0,0,0] row_mask:0xf bank_mask:0xf
    s_nop 1
    v_add_f32_dpp v28, v13, v28 quad_perm:[1,1,1,1] row_mask:0xf bank_mask:0xf
    s_nop 1
    v_add_f32_dpp v28, v14, v28 quad_perm:[2,2,2,2] row_mask:0xf bank_mask:0xf
    s_nop 1
    v_add_f32_dpp v28, v15, v28 quad_perm:[3,3,3,3] row_mask:0xf bank_mask:0xf
    s_xor_b32 s59, s46, 0x00018000
    v_xor_b32 v52, s59, v35
    s_waitcnt vmcnt(5)
    s_cbranch_vccnz 1
    s_waitcnt vmcnt(4)
    buffer_load_dwordx4 v[72:75], v52, s[40:43], 0 offen nt
    v_mfma_f32_16x16x32_bf16 v[12:15], v[112:115], v[4:7], 0
    v_mov_b32_dpp v29, v16 quad_perm:[0,0,0,0] row_mask:0xf bank_mask:0xf
    s_nop 1
    v_add_f32_dpp v29, v17, v29 quad_perm:[1,1,1,1] row_mask:0xf bank_mask:0xf
    s_nop 1
    v_add_f32_dpp v29, v18, v29 quad_perm:[2,2,2,2] row_mask:0xf bank_mask:0xf
    s_nop 1
    v_add_f32_dpp v29, v19, v29 quad_perm:[3,3,3,3] row_mask:0xf bank_mask:0xf
    v_cvt_pk_bf16_f32 v31, 0, v28
    v_cvt_pk_bf16_f32 v32, 0, v29
    v_mul_f32 v31, s50, v31
    v_mul_f32 v32, s50, v32
    v_cvt_pk_bf16_f32 v30, v31, v32
    v_max3_f32 v53, v53, v31, v32
    ds_write_b32 v54, v30 offset:768
    s_xor_b32 s59, s46, 0x00018300
    v_xor_b32 v52, s59, v35
    s_waitcnt vmcnt(4)
    buffer_load_dwordx4 v[76:79], v52, s[40:43], 0 offen nt
    v_mfma_f32_16x16x32_bf16 v[12:15], v[116:119], v[8:11], v[12:15]
    s_add_u32 s45, s45, 1
    s_or_b32 s44, s45, 32
    s_ff1_i32_b32 m0, s44
    s_nop 0
    s_movrels_b32 s44, s60
    s_xor_b32 s46, s46, s44
    v_xor_b32 v52, s46, v35
    s_waitcnt vmcnt(4)
    buffer_load_dwordx4 v[80:83], v52, s[40:43], 0 offen nt
    v_mfma_f32_16x16x32_bf16 v[16:19], v[120:123], v[4:7], 0
    s_xor_b32 s59, s46, 0x00000300
    v_xor_b32 v52, s59, v35
    s_waitcnt vmcnt(4)
    buffer_load_dwordx4 v[84:87], v52, s[40:43], 0 offen nt
    v_mfma_f32_16x16x32_bf16 v[16:19], v[124:127], v[8:11], v[16:19]
    v_mov_b32_dpp v28, v12 quad_perm:[0,0,0,0] row_mask:0xf bank_mask:0xf
    s_nop 1
    v_add_f32_dpp v28, v13, v28 quad_perm:[1,1,1,1] row_mask:0xf bank_mask:0xf
    s_nop 1
    v_add_f32_dpp v28, v14, v28 quad_perm:[2,2,2,2] row_mask:0xf bank_mask:0xf
    s_nop 1
    v_add_f32_dpp v28, v15, v28 quad_perm:[3,3,3,3] row_mask:0xf bank_mask:0xf
    v_mov_b32_dpp v29, v16 quad_perm:[0,0,0,0] row_mask:0xf bank_mask:0xf
    s_nop 1
    v_add_f32_dpp v29, v17, v29 quad_perm:[1,1,1,1] row_mask:0xf bank_mask:0xf
    s_nop 1
    v_add_f32_dpp v29, v18, v29 quad_perm:[2,2,2,2] row_mask:0xf bank_mask:0xf
    s_nop 1
    v_add_f32_dpp v29, v19, v29 quad_perm:[3,3,3,3] row_mask:0xf bank_mask:0xf
    v_cvt_pk_bf16_f32 v31, 0, v28
    v_cvt_pk_bf16_f32 v32, 0, v29
    v_mul_f32 v31, s50, v31
    v_mul_f32 v32, s50, v32
    v_cvt_pk_bf16_f32 v30, v31, v32
    v_max3_f32 v53, v53, v31, v32
    ds_write_b32 v54, v30 offset:1024
    s_nop 0
    v_max_f32_dpp v53, v53, v53 row_half_mirror row_mask:0xf bank_mask:0xf
    v_mov_b32 v28, v53
    s_nop 1
    v_permlane16_swap_b32 v53, v28
    v_max_f32 v53, v53, v28
    v_mov_b32 v28, v53
    s_nop 1
    v_permlane32_swap_b32 v53, v28
    v_max_f32 v53, v53, v28
    v_cvt_pk_bf16_f32 v53, 0, v53
    s_lshl_b32 s47, s3, 3
    v_add_u32 v28, s47, v56
    ds_write_b32 v28, v53
    ds_read_b32 v30, v55
    s_waitcnt lgkmcnt(0)
    v_lshlrev_b32 v31, 16, v30
    v_and_b32 v32, s52, v30
    ds_read_b32 v30, v55 offset:256
    v_sub_f32 v31, v31, v53
    v_sub_f32 v32, v32, v53
    v_mul_f32 v31, s51, v31
    v_mul_f32 v32, s51, v32
    v_exp_f32 v31, v31
    v_exp_f32 v32, v32
    v_cvt_pk_bf16_f32 v33, v31, v31
    v_cvt_pk_bf16_f32 v34, v32, v32
    v_and_b32 v44, v33, v36
    v_and_b32 v45, v33, v37
    v_and_b32_dpp v46, v33, v38 row_shr:4 row_mask:0xf bank_mask:0xf bound_ctrl:0
    v_and_b32_dpp v47, v33, v39 row_shr:4 row_mask:0xf bank_mask:0xf bound_ctrl:0
    s_mov_b32 s53, 13
L_vloop:
    s_nop 7
    s_xor_b32 s59, s46, 0x00018000
    v_xor_b32 v52, s59, v35
    s_waitcnt vmcnt(5)
    buffer_load_dwordx4 v[88:91], v52, s[40:43], 0 offen nt
    v_mfma_f32_16x16x32_bf16 v[40:43], v[64:67], v[44:47], v[40:43]
    v_and_b32 v50, v33, v38
    v_and_b32 v51, v33, v39
    v_and_b32_dpp v48, v33, v36 row_shl:4 row_mask:0xf bank_mask:0xf bound_ctrl:0
    v_and_b32_dpp v49, v33, v37 row_shl:4 row_mask:0xf bank_mask:0xf bound_ctrl:0
    s_xor_b32 s59, s46, 0x00018300
    v_xor_b32 v52, s59, v35
    s_waitcnt vmcnt(4)
    buffer_load_dwordx4 v[92:95], v52, s[40:43], 0 offen nt
    v_mfma_f32_16x16x32_bf16 v[40:43], v[68:71], v[48:51], v[40:43]
    v_and_b32 v44, v34, v36
    v_and_b32 v45, v34, v37
    v_and_b32_dpp v46, v34, v38 row_shr:4 row_mask:0xf bank_mask:0xf bound_ctrl:0
    v_and_b32_dpp v47, v34, v39 row_shr:4 row_mask:0xf bank_mask:0xf bound_ctrl:0
    s_add_u32 s45, s45, 1
    s_or_b32 s44, s45, 32
    s_ff1_i32_b32 m0, s44
    s_nop 0
    s_movrels_b32 s44, s60
    s_xor_b32 s46, s46, s44
    v_xor_b32 v52, s46, v35
    s_waitcnt vmcnt(5)
    s_cbranch_vccnz 1
    s_waitcnt vmcnt(4)
    buffer_load_dwordx4 v[96:99], v52, s[40:43], 0 offen nt
    v_mfma_f32_16x16x32_bf16 v[40:43], v[72:75], v[44:47], v[40:43]
    v_and_b32 v50, v34, v38
    v_and_b32 v51, v34, v39
    v_and_b32_dpp v48, v34, v36 row_shl:4 row_mask:0xf bank_mask:0xf bound_ctrl:0
    v_and_b32_dpp v49, v34, v37 row_shl:4 row_mask:0xf bank_mask:0xf bound_ctrl:0
    s_xor_b32 s59, s46, 0x00000300
    v_xor_b32 v52, s59, v35
    s_waitcnt vmcnt(4)
    buffer_load_dwordx4 v[100:103], v52, s[40:43], 0 offen nt
    v_mfma_f32_16x16x32_bf16 v[40:43], v[76:79], v[48:51], v[40:43]
    s_waitcnt lgkmcnt(0)
    v_lshlrev_b32 v31, 16, v30
    v_and_b32 v32, s52, v30
    ds_read_b32 v30, v55 offset:512
    v_sub_f32 v31, v31, v53
    v_sub_f32 v32, v32, v53
    v_mul_f32 v31, s51, v31
    v_mul_f32 v32, s51, v32
    v_exp_f32 v31, v31
    v_exp_f32 v32, v32
    v_cvt_pk_bf16_f32 v33, v31, v31
    v_cvt_pk_bf16_f32 v34, v32, v32
    v_and_b32 v44, v33, v36
    v_and_b32 v45, v33, v37
    v_and_b32_dpp v46, v33, v38 row_shr:4 row_mask:0xf bank_mask:0xf bound_ctrl:0
    v_and_b32_dpp v47, v33, v39 row_shr:4 row_mask:0xf bank_mask:0xf bound_ctrl:0
    s_xor_b32 s59, s46, 0x00018000
    v_xor_b32 v52, s59, v35
    s_waitcnt vmcnt(5)
    buffer_load_dwordx4 v[104:107], v52, s[40:43], 0 offen nt
    v_mfma_f32_16x16x32_bf16 v[40:43], v[80:83], v[44:47], v[40:43]
    v_and_b32 v50, v33, v38
    v_and_b32 v51, v33, v39
    v_and_b32_dpp v48, v33, v36 row_shl:4 row_mask:0xf bank_mask:0xf bound_ctrl:0
    v_and_b32_dpp v49, v33, v37 row_shl:4 row_mask:0xf bank_mask:0xf bound_ctrl:0
    s_xor_b32 s59, s46, 0x00018300
    v_xor_b32 v52, s59, v35
    s_waitcnt vmcnt(4)
    buffer_load_dwordx4 v[108:111], v52, s[40:43], 0 offen nt
    v_mfma_f32_16x16x32_bf16 v[40:43], v[84:87], v[48:51], v[40:43]
    v_and_b32 v44, v34, v36
    v_and_b32 v45, v34, v37
    v_and_b32_dpp v46, v34, v38 row_shr:4 row_mask:0xf bank_mask:0xf bound_ctrl:0
    v_and_b32_dpp v47, v34, v39 row_shr:4 row_mask:0xf bank_mask:0xf bound_ctrl:0
    s_add_u32 s45, s45, 1
    s_or_b32 s44, s45, 32
    s_ff1_i32_b32 m0, s44
    s_nop 0
    s_movrels_b32 s44, s60
    s_xor_b32 s46, s46, s44
    v_xor_b32 v52, s46, v35
    s_waitcnt vmcnt(4)
    buffer_load_dwordx4 v[112:115], v52, s[40:43], 0 offen nt
    v_mfma_f32_16x16x32_bf16 v[40:43], v[88:91], v[44:47], v[40:43]
    v_and_b32 v50, v34, v38
    v_and_b32 v51, v34, v39
    v_and_b32_dpp v48, v34, v36 row_shl:4 row_mask:0xf bank_mask:0xf bound_ctrl:0
    v_and_b32_dpp v49, v34, v37 row_shl:4 row_mask:0xf bank_mask:0xf bound_ctrl:0
    s_xor_b32 s59, s46, 0x00000300
    v_xor_b32 v52, s59, v35
    s_waitcnt vmcnt(4)
    buffer_load_dwordx4 v[116:119], v52, s[40:43], 0 offen nt
    v_mfma_f32_16x16x32_bf16 v[40:43], v[92:95], v[48:51], v[40:43]
    s_waitcnt lgkmcnt(0)
    v_lshlrev_b32 v31, 16, v30
    v_and_b32 v32, s52, v30
    ds_read_b32 v30, v55 offset:768
    v_sub_f32 v31, v31, v53
    v_sub_f32 v32, v32, v53
    v_mul_f32 v31, s51, v31
    v_mul_f32 v32, s51, v32
    v_exp_f32 v31, v31
    v_exp_f32 v32, v32
    v_cvt_pk_bf16_f32 v33, v31, v31
    v_cvt_pk_bf16_f32 v34, v32, v32
    v_and_b32 v44, v33, v36
    v_and_b32 v45, v33, v37
    v_and_b32_dpp v46, v33, v38 row_shr:4 row_mask:0xf bank_mask:0xf bound_ctrl:0
    v_and_b32_dpp v47, v33, v39 row_shr:4 row_mask:0xf bank_mask:0xf bound_ctrl:0
    s_xor_b32 s59, s46, 0x00018000
    v_xor_b32 v52, s59, v35
    s_waitcnt vmcnt(5)
    buffer_load_dwordx4 v[120:123], v52, s[40:43], 0 offen nt
    v_mfma_f32_16x16x32_bf16 v[40:43], v[96:99], v[44:47], v[40:43]
    v_and_b32 v50, v33, v38
    v_and_b32 v51, v33, v39
    v_and_b32_dpp v48, v33, v36 row_shl:4 row_mask:0xf bank_mask:0xf bound_ctrl:0
    v_and_b32_dpp v49, v33, v37 row_shl:4 row_mask:0xf bank_mask:0xf bound_ctrl:0
    s_xor_b32 s59, s46, 0x00018300
    v_xor_b32 v52, s59, v35
    s_waitcnt vmcnt(4)
    buffer_load_dwordx4 v[124:127], v52, s[40:43], 0 offen nt
    v_mfma_f32_16x16x32_bf16 v[40:43], v[100:103], v[48:51], v[40:43]
    v_and_b32 v44, v34, v36
    v_and_b32 v45, v34, v37
    v_and_b32_dpp v46, v34, v38 row_shr:4 row_mask:0xf bank_mask:0xf bound_ctrl:0
    v_and_b32_dpp v47, v34, v39 row_shr:4 row_mask:0xf bank_mask:0xf bound_ctrl:0
    s_add_u32 s45, s45, 1
    s_or_b32 s44, s45, 32
    s_ff1_i32_b32 m0, s44
    s_nop 0
    s_movrels_b32 s44, s60
    s_xor_b32 s46, s46, s44
    v_xor_b32 v52, s46, v35
    s_waitcnt vmcnt(4)
    buffer_load_dwordx4 v[64:67], v52, s[40:43], 0 offen nt
    v_mfma_f32_16x16x32_bf16 v[40:43], v[104:107], v[44:47], v[40:43]
    v_and_b32 v50, v34, v38
    v_and_b32 v51, v34, v39
    v_and_b32_dpp v48, v34, v36 row_shl:4 row_mask:0xf bank_mask:0xf bound_ctrl:0
    v_and_b32_dpp v49, v34, v37 row_shl:4 row_mask:0xf bank_mask:0xf bound_ctrl:0
    s_xor_b32 s59, s46, 0x00000300
    v_xor_b32 v52, s59, v35
    s_waitcnt vmcnt(4)
    buffer_load_dwordx4 v[68:71], v52, s[40:43], 0 offen nt
    v_mfma_f32_16x16x32_bf16 v[40:43], v[108:111], v[48:51], v[40:43]
    s_waitcnt lgkmcnt(0)
    v_lshlrev_b32 v31, 16, v30
    v_and_b32 v32, s52, v30
    ds_read_b32 v30, v55 offset:1024
    v_sub_f32 v31, v31, v53
    v_sub_f32 v32, v32, v53
    v_mul_f32 v31, s51, v31
    v_mul_f32 v32, s51, v32
    v_exp_f32 v31, v31
    v_exp_f32 v32, v32
    v_cvt_pk_bf16_f32 v33, v31, v31
    v_cvt_pk_bf16_f32 v34, v32, v32
    v_and_b32 v44, v33, v36
    v_and_b32 v45, v33, v37
    v_and_b32_dpp v46, v33, v38 row_shr:4 row_mask:0xf bank_mask:0xf bound_ctrl:0
    v_and_b32_dpp v47, v33, v39 row_shr:4 row_mask:0xf bank_mask:0xf bound_ctrl:0
    s_xor_b32 s59, s46, 0x00018000
    v_xor_b32 v52, s59, v35
    s_waitcnt vmcnt(5)
    s_cbranch_vccnz 1
    s_waitcnt vmcnt(4)
    buffer_load_dwordx4 v[72:75], v52, s[40:43], 0 offen nt
    v_mfma_f32_16x16x32_bf16 v[40:43], v[112:115], v[44:47], v[40:43]
    v_and_b32 v50, v33, v38
    v_and_b32 v51, v33, v39
    v_and_b32_dpp v48, v33, v36 row_shl:4 row_mask:0xf bank_mask:0xf bound_ctrl:0
    v_and_b32_dpp v49, v33, v37 row_shl:4 row_mask:0xf bank_mask:0xf bound_ctrl:0
    s_xor_b32 s59, s46, 0x00018300
    v_xor_b32 v52, s59, v35
    s_waitcnt vmcnt(4)
    buffer_load_dwordx4 v[76:79], v52, s[40:43], 0 offen nt
    v_mfma_f32_16x16x32_bf16 v[40:43], v[116:119], v[48:51], v[40:43]
    v_and_b32 v44, v34, v36
    v_and_b32 v45, v34, v37
    v_and_b32_dpp v46, v34, v38 row_shr:4 row_mask:0xf bank_mask:0xf bound_ctrl:0
    v_and_b32_dpp v47, v34, v39 row_shr:4 row_mask:0xf bank_mask:0xf bound_ctrl:0
    s_add_u32 s45, s45, 1
    s_or_b32 s44, s45, 32
    s_ff1_i32_b32 m0, s44
    s_nop 0
    s_movrels_b32 s44, s60
    s_xor_b32 s46, s46, s44
    v_xor_b32 v52, s46, v35
    s_waitcnt vmcnt(4)
    buffer_load_dwordx4 v[80:83], v52, s[40:43], 0 offen nt
    v_mfma_f32_16x16x32_bf16 v[40:43], v[120:123], v[44:47], v[40:43]
    v_and_b32 v50, v34, v38
    v_and_b32 v51, v34, v39
    v_and_b32_dpp v48, v34, v36 row_shl:4 row_mask:0xf bank_mask:0xf bound_ctrl:0
    v_and_b32_dpp v49, v34, v37 row_shl:4 row_mask:0xf bank_mask:0xf bound_ctrl:0
    s_xor_b32 s59, s46, 0x00000300
    v_xor_b32 v52, s59, v35
    s_waitcnt vmcnt(4)
    buffer_load_dwordx4 v[84:87], v52, s[40:43], 0 offen nt
    v_mfma_f32_16x16x32_bf16 v[40:43], v[124:127], v[48:51], v[40:43]
    s_waitcnt lgkmcnt(0)
    v_lshlrev_b32 v31, 16, v30
    v_and_b32 v32, s52, v30
    ds_read_b32 v30, v55 offset:1280
    v_sub_f32 v31, v31, v53
    v_sub_f32 v32, v32, v53
    v_mul_f32 v31, s51, v31
    v_mul_f32 v32, s51, v32
    v_exp_f32 v31, v31
    v_exp_f32 v32, v32
    v_cvt_pk_bf16_f32 v33, v31, v31
    v_cvt_pk_bf16_f32 v34, v32, v32
    v_and_b32 v44, v33, v36
    v_and_b32 v45, v33, v37
    v_and_b32_dpp v46, v33, v38 row_shr:4 row_mask:0xf bank_mask:0xf bound_ctrl:0
    v_and_b32_dpp v47, v33, v39 row_shr:4 row_mask:0xf bank_mask:0xf bound_ctrl:0
    v_add_u32 v55, 1024, v55
    s_sub_u32 s53, s53, 1
    s_cmp_lg_u32 s53, 0
    s_cbranch_scc1 L_vloop
    s_mov_b32 s54, 524288
L_gspin:
    s_nop 7
    ds_read2_b32 v[20:21], v56 offset0:16 offset1:18
    s_waitcnt lgkmcnt(0)
    v_max_u32 v22, v20, v21
    v_cmp_eq_u32 vcc, -1, v22
    s_nop 0
    s_cbranch_vccz L_gok
    s_sub_u32 s54, s54, 1
    s_cmp_lg_u32 s54, 0
    s_cbranch_scc1 L_gspin
L_gok:
    v_sub_f32 v57, v53, v20
    v_mul_f32 v57, s51, v57
    v_exp_f32 v57, v57
    s_nop 0
    v_mul_f32 v57, v57, v21
    s_lshl_b32 s47, s3, 10
    s_add_u32 s47, s47, 12288
    v_add_u32 v58, s47, v3
    s_mov_b32 s36, s28
    s_and_b32 s37, s29, 0xffff
    s_mov_b32 s38, 1048576
    s_mov_b32 s39, 0x20000
    v_bfe_u32 v24, v1, 3, 1
    v_lshlrev_b32 v24, 13, v24
    v_lshrrev_b32 v25, 4, v1
    v_lshl_add_u32 v24, v25, 11, v24
    v_and_b32 v25, 7, v1
    v_lshl_add_u32 v24, v25, 7, v24
    s_lshl_b32 s57, s33, 14
    s_lshl_b32 s56, s32, 10
    s_add_u32 s57, s57, s56
    s_lshl_b32 s56, s31, 4
    s_add_u32 s57, s57, s56
    s_add_u32 s57, s57, 262144
    v_mov_b32 v60, s35
    v_lshrrev_b32 v61, 8, v60
    v_lshrrev_b32 v62, 16, v60
    v_lshrrev_b32 v63, 24, v60
    s_movk_i32 s56, 0xff
    s_xor_b32 s59, s46, 0x00018000
    v_xor_b32 v52, s59, v35
    s_waitcnt vmcnt(5)
    buffer_load_dwordx4 v[128:131], v52, s[40:43], 0 offen nt
    s_xor_b32 s59, s46, 0x00018300
    v_xor_b32 v52, s59, v35
    buffer_load_dwordx4 v[132:135], v52, s[40:43], 0 offen nt
    v_mfma_f32_16x16x32_bf16 v[40:43], v[64:67], v[44:47], v[40:43]
    v_and_b32 v50, v33, v38
    v_and_b32 v51, v33, v39
    v_and_b32_dpp v48, v33, v36 row_shl:4 row_mask:0xf bank_mask:0xf bound_ctrl:0
    v_and_b32_dpp v49, v33, v37 row_shl:4 row_mask:0xf bank_mask:0xf bound_ctrl:0
    s_add_u32 s45, s45, 1
    s_or_b32 s44, s45, 32
    s_ff1_i32_b32 m0, s44
    s_nop 0
    s_movrels_b32 s44, s60
    s_xor_b32 s46, s46, s44
    v_xor_b32 v52, s46, v35
    s_waitcnt vmcnt(6)
    buffer_load_dwordx4 v[136:139], v52, s[40:43], 0 offen nt
    s_xor_b32 s59, s46, 0x00000300
    v_xor_b32 v52, s59, v35
    buffer_load_dwordx4 v[140:143], v52, s[40:43], 0 offen nt
    v_mfma_f32_16x16x32_bf16 v[40:43], v[68:71], v[48:51], v[40:43]
    v_and_b32 v44, v34, v36
    v_and_b32 v45, v34, v37
    v_and_b32_dpp v46, v34, v38 row_shr:4 row_mask:0xf bank_mask:0xf bound_ctrl:0
    v_and_b32_dpp v47, v34, v39 row_shr:4 row_mask:0xf bank_mask:0xf bound_ctrl:0
    s_xor_b32 s59, s46, 0x00018000
    v_xor_b32 v52, s59, v35
    s_waitcnt vmcnt(7)
    buffer_load_dwordx4 v[144:147], v52, s[40:43], 0 offen nt
    s_xor_b32 s59, s46, 0x00018300
    v_xor_b32 v52, s59, v35
    buffer_load_dwordx4 v[148:151], v52, s[40:43], 0 offen nt
    v_mfma_f32_16x16x32_bf16 v[40:43], v[72:75], v[44:47], v[40:43]
    v_and_b32 v50, v34, v38
    v_and_b32 v51, v34, v39
    v_and_b32_dpp v48, v34, v36 row_shl:4 row_mask:0xf bank_mask:0xf bound_ctrl:0
    v_and_b32_dpp v49, v34, v37 row_shl:4 row_mask:0xf bank_mask:0xf bound_ctrl:0
    s_add_u32 s45, s45, 1
    s_or_b32 s44, s45, 32
    s_ff1_i32_b32 m0, s44
    s_nop 0
    s_movrels_b32 s44, s60
    s_xor_b32 s46, s46, s44
    v_xor_b32 v52, s46, v35
    s_waitcnt vmcnt(8)
    buffer_load_dwordx4 v[152:155], v52, s[40:43], 0 offen nt
    s_xor_b32 s59, s46, 0x00000300
    v_xor_b32 v52, s59, v35
    buffer_load_dwordx4 v[156:159], v52, s[40:43], 0 offen nt
    v_mfma_f32_16x16x32_bf16 v[40:43], v[76:79], v[48:51], v[40:43]
    s_waitcnt lgkmcnt(0)
    v_lshlrev_b32 v31, 16, v30
    v_and_b32 v32, s52, v30
    ds_read_b32 v30, v55 offset:512
    v_sub_f32 v31, v31, v53
    v_sub_f32 v32, v32, v53
    v_mul_f32 v31, s51, v31
    v_mul_f32 v32, s51, v32
    v_exp_f32 v31, v31
    v_exp_f32 v32, v32
    v_cvt_pk_bf16_f32 v33, v31, v31
    v_cvt_pk_bf16_f32 v34, v32, v32
    v_and_b32 v44, v33, v36
    v_and_b32 v45, v33, v37
    v_and_b32_dpp v46, v33, v38 row_shr:4 row_mask:0xf bank_mask:0xf bound_ctrl:0
    v_and_b32_dpp v47, v33, v39 row_shr:4 row_mask:0xf bank_mask:0xf bound_ctrl:0
    s_xor_b32 s59, s46, 0x00018000
    v_xor_b32 v52, s59, v35
    s_waitcnt vmcnt(9)
    buffer_load_dwordx4 v[160:163], v52, s[40:43], 0 offen nt
    s_xor_b32 s59, s46, 0x00018300
    v_xor_b32 v52, s59, v35
    buffer_load_dwordx4 v[164:167], v52, s[40:43], 0 offen nt
    v_mfma_f32_16x16x32_bf16 v[40:43], v[80:83], v[44:47], v[40:43]
    v_and_b32 v50, v33, v38
    v_and_b32 v51, v33, v39
    v_and_b32_dpp v48, v33, v36 row_shl:4 row_mask:0xf bank_mask:0xf bound_ctrl:0
    v_and_b32_dpp v49, v33, v37 row_shl:4 row_mask:0xf bank_mask:0xf bound_ctrl:0
    s_add_u32 s45, s45, 1
    s_or_b32 s44, s45, 32
    s_ff1_i32_b32 m0, s44
    s_nop 0
    s_movrels_b32 s44, s60
    s_xor_b32 s46, s46, s44
    v_xor_b32 v52, s46, v35
    s_waitcnt vmcnt(10)
    buffer_load_dwordx4 v[168:171], v52, s[40:43], 0 offen nt
    s_xor_b32 s59, s46, 0x00000300
    v_xor_b32 v52, s59, v35
    buffer_load_dwordx4 v[172:175], v52, s[40:43], 0 offen nt
    v_mfma_f32_16x16x32_bf16 v[40:43], v[84:87], v[48:51], v[40:43]
    v_and_b32 v44, v34, v36
    v_and_b32 v45, v34, v37
    v_and_b32_dpp v46, v34, v38 row_shr:4 row_mask:0xf bank_mask:0xf bound_ctrl:0
    v_and_b32_dpp v47, v34, v39 row_shr:4 row_mask:0xf bank_mask:0xf bound_ctrl:0
    s_xor_b32 s59, s46, 0x00018000
    v_xor_b32 v52, s59, v35
    s_waitcnt vmcnt(11)
    buffer_load_dwordx4 v[176:179], v52, s[40:43], 0 offen nt
    s_xor_b32 s59, s46, 0x00018300
    v_xor_b32 v52, s59, v35
    buffer_load_dwordx4 v[180:183], v52, s[40:43], 0 offen nt
    v_mfma_f32_16x16x32_bf16 v[40:43], v[128:131], v[44:47], v[40:43]
    v_and_b32 v50, v34, v38
    v_and_b32 v51, v34, v39
    v_and_b32_dpp v48, v34, v36 row_shl:4 row_mask:0xf bank_mask:0xf bound_ctrl:0
    v_and_b32_dpp v49, v34, v37 row_shl:4 row_mask:0xf bank_mask:0xf bound_ctrl:0
    s_add_u32 s45, s45, 1
    s_or_b32 s44, s45, 32
    s_ff1_i32_b32 m0, s44
    s_nop 0
    s_movrels_b32 s44, s60
    s_xor_b32 s46, s46, s44
    v_xor_b32 v52, s46, v35
    s_waitcnt vmcnt(12)
    buffer_load_dwordx4 v[184:187], v52, s[40:43], 0 offen nt
    s_xor_b32 s59, s46, 0x00000300
    v_xor_b32 v52, s59, v35
    buffer_load_dwordx4 v[188:191], v52, s[40:43], 0 offen nt
    v_mfma_f32_16x16x32_bf16 v[40:43], v[132:135], v[48:51], v[40:43]
    s_waitcnt lgkmcnt(0)
    v_lshlrev_b32 v31, 16, v30
    v_and_b32 v32, s52, v30
    ds_read_b32 v30, v55 offset:768
    v_sub_f32 v31, v31, v53
    v_sub_f32 v32, v32, v53
    v_mul_f32 v31, s51, v31
    v_mul_f32 v32, s51, v32
    v_exp_f32 v31, v31
    v_exp_f32 v32, v32
    v_cvt_pk_bf16_f32 v33, v31, v31
    v_cvt_pk_bf16_f32 v34, v32, v32
    v_and_b32 v44, v33, v36
    v_and_b32 v45, v33, v37
    v_and_b32_dpp v46, v33, v38 row_shr:4 row_mask:0xf bank_mask:0xf bound_ctrl:0
    v_and_b32_dpp v47, v33, v39 row_shr:4 row_mask:0xf bank_mask:0xf bound_ctrl:0
    s_xor_b32 s59, s46, 0x00018000
    v_xor_b32 v52, s59, v35
    s_waitcnt vmcnt(13)
    buffer_load_dwordx4 v[192:195], v52, s[40:43], 0 offen nt
    s_xor_b32 s59, s46, 0x00018300
    v_xor_b32 v52, s59, v35
    buffer_load_dwordx4 v[196:199], v52, s[40:43], 0 offen nt
    v_mfma_f32_16x16x32_bf16 v[40:43], v[136:139], v[44:47], v[40:43]
    v_and_b32 v50, v33, v38
    v_and_b32 v51, v33, v39
    v_and_b32_dpp v48, v33, v36 row_shl:4 row_mask:0xf bank_mask:0xf bound_ctrl:0
    v_and_b32_dpp v49, v33, v37 row_shl:4 row_mask:0xf bank_mask:0xf bound_ctrl:0
    s_add_u32 s45, s45, 1
    s_or_b32 s44, s45, 32
    s_ff1_i32_b32 m0, s44
    s_nop 0
    s_movrels_b32 s44, s60
    s_xor_b32 s46, s46, s44
    v_xor_b32 v52, s46, v35
    s_waitcnt vmcnt(14)
    buffer_load_dwordx4 v[200:203], v52, s[40:43], 0 offen nt
    s_xor_b32 s59, s46, 0x00000300
    v_xor_b32 v52, s59, v35
    buffer_load_dwordx4 v[204:207], v52, s[40:43], 0 offen nt
    v_mfma_f32_16x16x32_bf16 v[40:43], v[140:143], v[48:51], v[40:43]
    v_and_b32 v44, v34, v36
    v_and_b32 v45, v34, v37
    v_and_b32_dpp v46, v34, v38 row_shr:4 row_mask:0xf bank_mask:0xf bound_ctrl:0
    v_and_b32_dpp v47, v34, v39 row_shr:4 row_mask:0xf bank_mask:0xf bound_ctrl:0
    s_xor_b32 s59, s46, 0x00018000
    v_xor_b32 v52, s59, v35
    s_waitcnt vmcnt(15)
    buffer_load_dwordx4 v[208:211], v52, s[40:43], 0 offen nt
    s_xor_b32 s59, s46, 0x00018300
    v_xor_b32 v52, s59, v35
    buffer_load_dwordx4 v[212:215], v52, s[40:43], 0 offen nt
    v_mfma_f32_16x16x32_bf16 v[40:43], v[144:147], v[44:47], v[40:43]
    v_and_b32 v50, v34, v38
    v_and_b32 v51, v34, v39
    v_and_b32_dpp v48, v34, v36 row_shl:4 row_mask:0xf bank_mask:0xf bound_ctrl:0
    v_and_b32_dpp v49, v34, v37 row_shl:4 row_mask:0xf bank_mask:0xf bound_ctrl:0
    s_add_u32 s45, s45, 1
    s_or_b32 s44, s45, 32
    s_ff1_i32_b32 m0, s44
    s_nop 0
    s_movrels_b32 s44, s60
    s_xor_b32 s46, s46, s44
    v_xor_b32 v52, s46, v35
    s_waitcnt vmcnt(16)
    buffer_load_dwordx4 v[216:219], v52, s[40:43], 0 offen nt
    s_xor_b32 s59, s46, 0x00000300
    v_xor_b32 v52, s59, v35
    buffer_load_dwordx4 v[220:223], v52, s[40:43], 0 offen nt
    v_mfma_f32_16x16x32_bf16 v[40:43], v[148:151], v[48:51], v[40:43]
    s_waitcnt lgkmcnt(0)
    v_lshlrev_b32 v31, 16, v30
    v_and_b32 v32, s52, v30
    ds_read_b32 v30, v55 offset:1024
    v_sub_f32 v31, v31, v53
    v_sub_f32 v32, v32, v53
    v_mul_f32 v31, s51, v31
    v_mul_f32 v32, s51, v32
    v_exp_f32 v31, v31
    v_exp_f32 v32, v32
    v_cvt_pk_bf16_f32 v33, v31, v31
    v_cvt_pk_bf16_f32 v34, v32, v32
    v_and_b32 v44, v33, v36
    v_and_b32 v45, v33, v37
    v_and_b32_dpp v46, v33, v38 row_shr:4 row_mask:0xf bank_mask:0xf bound_ctrl:0
    v_and_b32_dpp v47, v33, v39 row_shr:4 row_mask:0xf bank_mask:0xf bound_ctrl:0
    s_xor_b32 s59, s46, 0x00018000
    v_xor_b32 v52, s59, v35
    s_waitcnt vmcnt(17)
    buffer_load_dwordx4 v[224:227], v52, s[40:43], 0 offen nt
    s_xor_b32 s59, s46, 0x00018300
    v_xor_b32 v52, s59, v35
    buffer_load_dwordx4 v[228:231], v52, s[40:43], 0 offen nt
    v_mfma_f32_16x16x32_bf16 v[40:43], v[152:155], v[44:47], v[40:43]
    v_and_b32 v50, v33, v38
    v_and_b32 v51, v33, v39
    v_and_b32_dpp v48, v33, v36 row_shl:4 row_mask:0xf bank_mask:0xf bound_ctrl:0
    v_and_b32_dpp v49, v33, v37 row_shl:4 row_mask:0xf bank_mask:0xf bound_ctrl:0
    s_add_u32 s45, s45, 1
    s_or_b32 s44, s45, 32
    s_ff1_i32_b32 m0, s44
    s_nop 0
    s_movrels_b32 s44, s60
    s_xor_b32 s46, s46, s44
    v_xor_b32 v52, s46, v35
    s_waitcnt vmcnt(18)
    buffer_load_dwordx4 v[232:235], v52, s[40:43], 0 offen nt
    s_xor_b32 s59, s46, 0x00000300
    v_xor_b32 v52, s59, v35
    buffer_load_dwordx4 v[236:239], v52, s[40:43], 0 offen nt
    v_mfma_f32_16x16x32_bf16 v[40:43], v[156:159], v[48:51], v[40:43]
    v_and_b32 v44, v34, v36
    v_and_b32 v45, v34, v37
    v_and_b32_dpp v46, v34, v38 row_shr:4 row_mask:0xf bank_mask:0xf bound_ctrl:0
    v_and_b32_dpp v47, v34, v39 row_shr:4 row_mask:0xf bank_mask:0xf bound_ctrl:0
    s_xor_b32 s59, s46, 0x00018000
    v_xor_b32 v52, s59, v35
    s_waitcnt vmcnt(19)
    buffer_load_dwordx4 v[240:243], v52, s[40:43], 0 offen nt
    v_mfma_f32_16x16x32_bf16 v[40:43], v[160:163], v[44:47], v[40:43]
    v_and_b32 v50, v34, v38
    v_and_b32 v51, v34, v39
    v_and_b32_dpp v48, v34, v36 row_shl:4 row_mask:0xf bank_mask:0xf bound_ctrl:0
    v_and_b32_dpp v49, v34, v37 row_shl:4 row_mask:0xf bank_mask:0xf bound_ctrl:0
    s_xor_b32 s59, s46, 0x00018300
    v_xor_b32 v52, s59, v35
    s_waitcnt vmcnt(19)
    buffer_load_dwordx4 v[244:247], v52, s[40:43], 0 offen nt
    v_mfma_f32_16x16x32_bf16 v[40:43], v[164:167], v[48:51], v[40:43]
    s_waitcnt lgkmcnt(0)
    v_lshlrev_b32 v31, 16, v30
    v_and_b32 v32, s52, v30
    ds_read_b32 v30, v55 offset:1280
    v_sub_f32 v31, v31, v53
    v_sub_f32 v32, v32, v53
    v_mul_f32 v31, s51, v31
    v_mul_f32 v32, s51, v32
    v_exp_f32 v31, v31
    v_exp_f32 v32, v32
    v_cvt_pk_bf16_f32 v33, v31, v31
    v_cvt_pk_bf16_f32 v34, v32, v32
    v_and_b32 v44, v33, v36
    v_and_b32 v45, v33, v37
    v_and_b32_dpp v46, v33, v38 row_shr:4 row_mask:0xf bank_mask:0xf bound_ctrl:0
    v_and_b32_dpp v47, v33, v39 row_shr:4 row_mask:0xf bank_mask:0xf bound_ctrl:0
    s_add_u32 s45, s45, 1
    s_or_b32 s44, s45, 32
    s_ff1_i32_b32 m0, s44
    s_nop 0
    s_movrels_b32 s44, s60
    s_xor_b32 s46, s46, s44
    v_xor_b32 v52, s46, v35
    s_waitcnt vmcnt(19)
    buffer_load_dwordx4 v[248:251], v52, s[40:43], 0 offen nt
    v_mfma_f32_16x16x32_bf16 v[40:43], v[168:171], v[44:47], v[40:43]
    v_and_b32 v50, v33, v38
    v_and_b32 v51, v33, v39
    v_and_b32_dpp v48, v33, v36 row_shl:4 row_mask:0xf bank_mask:0xf bound_ctrl:0
    v_and_b32_dpp v49, v33, v37 row_shl:4 row_mask:0xf bank_mask:0xf bound_ctrl:0
    s_xor_b32 s59, s46, 0x00000300
    v_xor_b32 v52, s59, v35
    s_waitcnt vmcnt(19)
    buffer_load_dwordx4 v[252:255], v52, s[40:43], 0 offen nt
    v_mfma_f32_16x16x32_bf16 v[40:43], v[172:175], v[48:51], v[40:43]
    v_and_b32 v44, v34, v36
    v_and_b32 v45, v34, v37
    v_and_b32_dpp v46, v34, v38 row_shr:4 row_mask:0xf bank_mask:0xf bound_ctrl:0
    v_and_b32_dpp v47, v34, v39 row_shr:4 row_mask:0xf bank_mask:0xf bound_ctrl:0
    s_xor_b32 s59, s46, 0x00018000
    v_xor_b32 v52, s59, v35
    s_waitcnt vmcnt(19)
    buffer_load_dwordx4 v[128:131], v52, s[40:43], 0 offen nt
    v_mfma_f32_16x16x32_bf16 v[40:43], v[176:179], v[44:47], v[40:43]
    v_and_b32 v50, v34, v38
    v_and_b32 v51, v34, v39
    v_and_b32_dpp v48, v34, v36 row_shl:4 row_mask:0xf bank_mask:0xf bound_ctrl:0
    v_and_b32_dpp v49, v34, v37 row_shl:4 row_mask:0xf bank_mask:0xf bound_ctrl:0
    s_xor_b32 s59, s46, 0x00018300
    v_xor_b32 v52, s59, v35
    s_waitcnt vmcnt(19)
    buffer_load_dwordx4 v[132:135], v52, s[40:43], 0 offen nt
    v_mfma_f32_16x16x32_bf16 v[40:43], v[180:183], v[48:51], v[40:43]
    s_waitcnt lgkmcnt(0)
    v_lshlrev_b32 v31, 16, v30
    v_and_b32 v32, s52, v30
    ds_read_b32 v30, v55 offset:1536
    v_sub_f32 v31, v31, v53
    v_sub_f32 v32, v32, v53
    v_mul_f32 v31, s51, v31
    v_mul_f32 v32, s51, v32
    v_exp_f32 v31, v31
    v_exp_f32 v32, v32
    v_cvt_pk_bf16_f32 v33, v31, v31
    v_cvt_pk_bf16_f32 v34, v32, v32
    v_and_b32 v44, v33, v36
    v_and_b32 v45, v33, v37
    v_and_b32_dpp v46, v33, v38 row_shr:4 row_mask:0xf bank_mask:0xf bound_ctrl:0
    v_and_b32_dpp v47, v33, v39 row_shr:4 row_mask:0xf bank_mask:0xf bound_ctrl:0
    s_add_u32 s45, s45, 1
    s_or_b32 s44, s45, 32
    s_ff1_i32_b32 m0, s44
    s_nop 0
    s_movrels_b32 s44, s60
    s_xor_b32 s46, s46, s44
    v_xor_b32 v52, s46, v35
    s_waitcnt vmcnt(19)
    buffer_load_dwordx4 v[136:139], v52, s[40:43], 0 offen nt
    v_mfma_f32_16x16x32_bf16 v[40:43], v[184:187], v[44:47], v[40:43]
    v_and_b32 v50, v33, v38
    v_and_b32 v51, v33, v39
    v_and_b32_dpp v48, v33, v36 row_shl:4 row_mask:0xf bank_mask:0xf bound_ctrl:0
    v_and_b32_dpp v49, v33, v37 row_shl:4 row_mask:0xf bank_mask:0xf bound_ctrl:0
    s_xor_b32 s59, s46, 0x00000300
    v_xor_b32 v52, s59, v35
    s_waitcnt vmcnt(19)
    buffer_load_dwordx4 v[140:143], v52, s[40:43], 0 offen nt
    v_mfma_f32_16x16x32_bf16 v[40:43], v[188:191], v[48:51], v[40:43]
    v_and_b32 v44, v34, v36
    v_and_b32 v45, v34, v37
    v_and_b32_dpp v46, v34, v38 row_shr:4 row_mask:0xf bank_mask:0xf bound_ctrl:0
    v_and_b32_dpp v47, v34, v39 row_shr:4 row_mask:0xf bank_mask:0xf bound_ctrl:0
    s_xor_b32 s59, s46, 0x00018000
    v_xor_b32 v52, s59, v35
    s_waitcnt vmcnt(19)
    buffer_load_dwordx4 v[144:147], v52, s[40:43], 0 offen nt
    v_mfma_f32_16x16x32_bf16 v[40:43], v[192:195], v[44:47], v[40:43]
    v_and_b32 v50, v34, v38
    v_and_b32 v51, v34, v39
    v_and_b32_dpp v48, v34, v36 row_shl:4 row_mask:0xf bank_mask:0xf bound_ctrl:0
    v_and_b32_dpp v49, v34, v37 row_shl:4 row_mask:0xf bank_mask:0xf bound_ctrl:0
    s_xor_b32 s59, s46, 0x00018300
    v_xor_b32 v52, s59, v35
    s_waitcnt vmcnt(19)
    buffer_load_dwordx4 v[148:151], v52, s[40:43], 0 offen nt
    v_mfma_f32_16x16x32_bf16 v[40:43], v[196:199], v[48:51], v[40:43]
    s_waitcnt lgkmcnt(0)
    v_lshlrev_b32 v31, 16, v30
    v_and_b32 v32, s52, v30
    ds_read_b32 v30, v55 offset:1792
    v_sub_f32 v31, v31, v53
    v_sub_f32 v32, v32, v53
    v_mul_f32 v31, s51, v31
    v_mul_f32 v32, s51, v32
    v_exp_f32 v31, v31
    v_exp_f32 v32, v32
    v_cvt_pk_bf16_f32 v33, v31, v31
    v_cvt_pk_bf16_f32 v34, v32, v32
    v_and_b32 v44, v33, v36
    v_and_b32 v45, v33, v37
    v_and_b32_dpp v46, v33, v38 row_shr:4 row_mask:0xf bank_mask:0xf bound_ctrl:0
    v_and_b32_dpp v47, v33, v39 row_shr:4 row_mask:0xf bank_mask:0xf bound_ctrl:0
    s_add_u32 s45, s45, 1
    s_or_b32 s44, s45, 32
    s_ff1_i32_b32 m0, s44
    s_nop 0
    s_movrels_b32 s44, s60
    s_xor_b32 s46, s46, s44
    v_xor_b32 v52, s46, v35
    s_waitcnt vmcnt(19)
    buffer_load_dwordx4 v[152:155], v52, s[40:43], 0 offen nt
    v_mfma_f32_16x16x32_bf16 v[40:43], v[200:203], v[44:47], v[40:43]
    v_and_b32 v50, v33, v38
    v_and_b32 v51, v33, v39
    v_and_b32_dpp v48, v33, v36 row_shl:4 row_mask:0xf bank_mask:0xf bound_ctrl:0
    v_and_b32_dpp v49, v33, v37 row_shl:4 row_mask:0xf bank_mask:0xf bound_ctrl:0
    s_xor_b32 s59, s46, 0x00000300
    v_xor_b32 v52, s59, v35
    s_waitcnt vmcnt(19)
    buffer_load_dwordx4 v[156:159], v52, s[40:43], 0 offen nt
    v_mfma_f32_16x16x32_bf16 v[40:43], v[204:207], v[48:51], v[40:43]
    v_and_b32 v44, v34, v36
    v_and_b32 v45, v34, v37
    v_and_b32_dpp v46, v34, v38 row_shr:4 row_mask:0xf bank_mask:0xf bound_ctrl:0
    v_and_b32_dpp v47, v34, v39 row_shr:4 row_mask:0xf bank_mask:0xf bound_ctrl:0
    s_xor_b32 s59, s46, 0x00018000
    v_xor_b32 v52, s59, v35
    s_waitcnt vmcnt(19)
    buffer_load_dwordx4 v[160:163], v52, s[40:43], 0 offen nt
    v_mfma_f32_16x16x32_bf16 v[40:43], v[208:211], v[44:47], v[40:43]
    v_and_b32 v50, v34, v38
    v_and_b32 v51, v34, v39
    v_and_b32_dpp v48, v34, v36 row_shl:4 row_mask:0xf bank_mask:0xf bound_ctrl:0
    v_and_b32_dpp v49, v34, v37 row_shl:4 row_mask:0xf bank_mask:0xf bound_ctrl:0
    s_xor_b32 s59, s46, 0x00018300
    v_xor_b32 v52, s59, v35
    s_waitcnt vmcnt(19)
    buffer_load_dwordx4 v[164:167], v52, s[40:43], 0 offen nt
    v_mfma_f32_16x16x32_bf16 v[40:43], v[212:215], v[48:51], v[40:43]
    s_waitcnt lgkmcnt(0)
    v_lshlrev_b32 v31, 16, v30
    v_and_b32 v32, s52, v30
    ds_read_b32 v30, v55 offset:2048
    v_sub_f32 v31, v31, v53
    v_sub_f32 v32, v32, v53
    v_mul_f32 v31, s51, v31
    v_mul_f32 v32, s51, v32
    v_exp_f32 v31, v31
    v_exp_f32 v32, v32
    v_cvt_pk_bf16_f32 v33, v31, v31
    v_cvt_pk_bf16_f32 v34, v32, v32
    v_and_b32 v44, v33, v36
    v_and_b32 v45, v33, v37
    v_and_b32_dpp v46, v33, v38 row_shr:4 row_mask:0xf bank_mask:0xf bound_ctrl:0
    v_and_b32_dpp v47, v33, v39 row_shr:4 row_mask:0xf bank_mask:0xf bound_ctrl:0
    s_waitcnt vmcnt(19)
    s_nop 0
    v_mfma_f32_16x16x32_bf16 v[40:43], v[216:219], v[44:47], v[40:43]
    v_and_b32 v50, v33, v38
    v_and_b32 v51, v33, v39
    v_and_b32_dpp v48, v33, v36 row_shl:4 row_mask:0xf bank_mask:0xf bound_ctrl:0
    v_and_b32_dpp v49, v33, v37 row_shl:4 row_mask:0xf bank_mask:0xf bound_ctrl:0
    s_waitcnt vmcnt(18)
    s_nop 0
    v_mfma_f32_16x16x32_bf16 v[40:43], v[220:223], v[48:51], v[40:43]
    v_and_b32 v44, v34, v36
    v_and_b32 v45, v34, v37
    v_and_b32_dpp v46, v34, v38 row_shr:4 row_mask:0xf bank_mask:0xf bound_ctrl:0
    v_and_b32_dpp v47, v34, v39 row_shr:4 row_mask:0xf bank_mask:0xf bound_ctrl:0
    s_waitcnt vmcnt(17)
    s_nop 0
    v_mfma_f32_16x16x32_bf16 v[40:43], v[224:227], v[44:47], v[40:43]
    v_and_b32 v50, v34, v38
    v_and_b32 v51, v34, v39
    v_and_b32_dpp v48, v34, v36 row_shl:4 row_mask:0xf bank_mask:0xf bound_ctrl:0
    v_and_b32_dpp v49, v34, v37 row_shl:4 row_mask:0xf bank_mask:0xf bound_ctrl:0
    s_waitcnt vmcnt(16)
    s_nop 0
    v_mfma_f32_16x16x32_bf16 v[40:43], v[228:231], v[48:51], v[40:43]
    s_waitcnt lgkmcnt(0)
    v_lshlrev_b32 v31, 16, v30
    v_and_b32 v32, s52, v30
    ds_read_b32 v30, v55 offset:2304
    v_sub_f32 v31, v31, v53
    v_sub_f32 v32, v32, v53
    v_mul_f32 v31, s51, v31
    v_mul_f32 v32, s51, v32
    v_exp_f32 v31, v31
    v_exp_f32 v32, v32
    v_cvt_pk_bf16_f32 v33, v31, v31
    v_cvt_pk_bf16_f32 v34, v32, v32
    v_and_b32 v44, v33, v36
    v_and_b32 v45, v33, v37
    v_and_b32_dpp v46, v33, v38 row_shr:4 row_mask:0xf bank_mask:0xf bound_ctrl:0
    v_and_b32_dpp v47, v33, v39 row_shr:4 row_mask:0xf bank_mask:0xf bound_ctrl:0
    s_waitcnt vmcnt(15)
    s_barrier
    v_mfma_f32_16x16x32_bf16 v[40:43], v[232:235], v[44:47], v[40:43]
    v_and_b32 v50, v33, v38
    v_and_b32 v51, v33, v39
    v_and_b32_dpp v48, v33, v36 row_shl:4 row_mask:0xf bank_mask:0xf bound_ctrl:0
    v_and_b32_dpp v49, v33, v37 row_shl:4 row_mask:0xf bank_mask:0xf bound_ctrl:0
    s_waitcnt vmcnt(14)
    s_nop 0
    v_mfma_f32_16x16x32_bf16 v[40:43], v[236:239], v[48:51], v[40:43]
    v_and_b32 v44, v34, v36
    v_and_b32 v45, v34, v37
    v_and_b32_dpp v46, v34, v38 row_shr:4 row_mask:0xf bank_mask:0xf bound_ctrl:0
    v_and_b32_dpp v47, v34, v39 row_shr:4 row_mask:0xf bank_mask:0xf bound_ctrl:0
    s_waitcnt vmcnt(13)
    s_nop 0
    v_mfma_f32_16x16x32_bf16 v[40:43], v[240:243], v[44:47], v[40:43]
    v_and_b32 v50, v34, v38
    v_and_b32 v51, v34, v39
    v_and_b32_dpp v48, v34, v36 row_shl:4 row_mask:0xf bank_mask:0xf bound_ctrl:0
    v_and_b32_dpp v49, v34, v37 row_shl:4 row_mask:0xf bank_mask:0xf bound_ctrl:0
    s_waitcnt vmcnt(12)
    s_nop 0
    v_mfma_f32_16x16x32_bf16 v[40:43], v[244:247], v[48:51], v[40:43]
    s_waitcnt lgkmcnt(0)
    v_lshlrev_b32 v31, 16, v30
    v_and_b32 v32, s52, v30
    ds_read_b32 v30, v55 offset:2560
    v_sub_f32 v31, v31, v53
    v_sub_f32 v32, v32, v53
    v_mul_f32 v31, s51, v31
    v_mul_f32 v32, s51, v32
    v_exp_f32 v31, v31
    v_exp_f32 v32, v32
    v_cvt_pk_bf16_f32 v33, v31, v31
    v_cvt_pk_bf16_f32 v34, v32, v32
    v_and_b32 v44, v33, v36
    v_and_b32 v45, v33, v37
    v_and_b32_dpp v46, v33, v38 row_shr:4 row_mask:0xf bank_mask:0xf bound_ctrl:0
    v_and_b32_dpp v47, v33, v39 row_shr:4 row_mask:0xf bank_mask:0xf bound_ctrl:0
    s_waitcnt vmcnt(11)
    s_nop 0
    v_mfma_f32_16x16x32_bf16 v[40:43], v[248:251], v[44:47], v[40:43]
    v_and_b32 v50, v33, v38
    v_and_b32 v51, v33, v39
    v_and_b32_dpp v48, v33, v36 row_shl:4 row_mask:0xf bank_mask:0xf bound_ctrl:0
    v_and_b32_dpp v49, v33, v37 row_shl:4 row_mask:0xf bank_mask:0xf bound_ctrl:0
    s_waitcnt vmcnt(10)
    s_nop 0
    v_mfma_f32_16x16x32_bf16 v[40:43], v[252:255], v[48:51], v[40:43]
    v_and_b32 v44, v34, v36
    v_and_b32 v45, v34, v37
    v_and_b32_dpp v46, v34, v38 row_shr:4 row_mask:0xf bank_mask:0xf bound_ctrl:0
    v_and_b32_dpp v47, v34, v39 row_shr:4 row_mask:0xf bank_mask:0xf bound_ctrl:0
    s_waitcnt vmcnt(9)
    s_nop 0
    v_mfma_f32_16x16x32_bf16 v[40:43], v[128:131], v[44:47], v[40:43]
    v_and_b32 v50, v34, v38
    v_and_b32 v51, v34, v39
    v_and_b32_dpp v48, v34, v36 row_shl:4 row_mask:0xf bank_mask:0xf bound_ctrl:0
    v_and_b32_dpp v49, v34, v37 row_shl:4 row_mask:0xf bank_mask:0xf bound_ctrl:0
    s_waitcnt vmcnt(8)
    s_nop 0
    v_mfma_f32_16x16x32_bf16 v[40:43], v[132:135], v[48:51], v[40:43]
    s_waitcnt lgkmcnt(0)
    v_lshlrev_b32 v31, 16, v30
    v_and_b32 v32, s52, v30
    ds_read_b32 v30, v55 offset:2816
    v_sub_f32 v31, v31, v53
    v_sub_f32 v32, v32, v53
    v_mul_f32 v31, s51, v31
    v_mul_f32 v32, s51, v32
    v_exp_f32 v31, v31
    v_exp_f32 v32, v32
    v_cvt_pk_bf16_f32 v33, v31, v31
    v_cvt_pk_bf16_f32 v34, v32, v32
    v_and_b32 v44, v33, v36
    v_and_b32 v45, v33, v37
    v_and_b32_dpp v46, v33, v38 row_shr:4 row_mask:0xf bank_mask:0xf bound_ctrl:0
    v_and_b32_dpp v47, v33, v39 row_shr:4 row_mask:0xf bank_mask:0xf bound_ctrl:0
    s_waitcnt vmcnt(7)
    s_nop 0
    v_mfma_f32_16x16x32_bf16 v[40:43], v[136:139], v[44:47], v[40:43]
    v_and_b32 v50, v33, v38
    v_and_b32 v51, v33, v39
    v_and_b32_dpp v48, v33, v36 row_shl:4 row_mask:0xf bank_mask:0xf bound_ctrl:0
    v_and_b32_dpp v49, v33, v37 row_shl:4 row_mask:0xf bank_mask:0xf bound_ctrl:0
    s_waitcnt vmcnt(6)
    s_nop 0
    v_mfma_f32_16x16x32_bf16 v[40:43], v[140:143], v[48:51], v[40:43]
    v_and_b32 v44, v34, v36
    v_and_b32 v45, v34, v37
    v_and_b32_dpp v46, v34, v38 row_shr:4 row_mask:0xf bank_mask:0xf bound_ctrl:0
    v_and_b32_dpp v47, v34, v39 row_shr:4 row_mask:0xf bank_mask:0xf bound_ctrl:0
    s_waitcnt vmcnt(5)
    s_nop 0
    v_mfma_f32_16x16x32_bf16 v[40:43], v[144:147], v[44:47], v[40:43]
    v_and_b32 v50, v34, v38
    v_and_b32 v51, v34, v39
    v_and_b32_dpp v48, v34, v36 row_shl:4 row_mask:0xf bank_mask:0xf bound_ctrl:0
    v_and_b32_dpp v49, v34, v37 row_shl:4 row_mask:0xf bank_mask:0xf bound_ctrl:0
    s_waitcnt vmcnt(4)
    s_nop 0
    v_mfma_f32_16x16x32_bf16 v[40:43], v[148:151], v[48:51], v[40:43]
    s_waitcnt lgkmcnt(0)
    v_lshlrev_b32 v31, 16, v30
    v_and_b32 v32, s52, v30
    v_sub_f32 v31, v31, v53
    v_sub_f32 v32, v32, v53
    v_mul_f32 v31, s51, v31
    v_mul_f32 v32, s51, v32
    v_exp_f32 v31, v31
    v_exp_f32 v32, v32
    v_cvt_pk_bf16_f32 v33, v31, v31
    v_cvt_pk_bf16_f32 v34, v32, v32
    v_and_b32 v44, v33, v36
    v_and_b32 v45, v33, v37
    v_and_b32_dpp v46, v33, v38 row_shr:4 row_mask:0xf bank_mask:0xf bound_ctrl:0
    v_and_b32_dpp v47, v33, v39 row_shr:4 row_mask:0xf bank_mask:0xf bound_ctrl:0
    s_waitcnt vmcnt(3)
    s_nop 0
    v_mfma_f32_16x16x32_bf16 v[40:43], v[152:155], v[44:47], v[40:43]
    v_and_b32 v50, v33, v38
    v_and_b32 v51, v33, v39
    v_and_b32_dpp v48, v33, v36 row_shl:4 row_mask:0xf bank_mask:0xf bound_ctrl:0
    v_and_b32_dpp v49, v33, v37 row_shl:4 row_mask:0xf bank_mask:0xf bound_ctrl:0
    s_waitcnt vmcnt(2)
    s_nop 0
    v_mfma_f32_16x16x32_bf16 v[40:43], v[156:159], v[48:51], v[40:43]
    v_and_b32 v44, v34, v36
    v_and_b32 v45, v34, v37
    v_and_b32_dpp v46, v34, v38 row_shr:4 row_mask:0xf bank_mask:0xf bound_ctrl:0
    v_and_b32_dpp v47, v34, v39 row_shr:4 row_mask:0xf bank_mask:0xf bound_ctrl:0
    s_waitcnt vmcnt(1)
    s_nop 0
    v_mfma_f32_16x16x32_bf16 v[40:43], v[160:163], v[44:47], v[40:43]
    v_and_b32 v50, v34, v38
    v_and_b32 v51, v34, v39
    v_and_b32_dpp v48, v34, v36 row_shl:4 row_mask:0xf bank_mask:0xf bound_ctrl:0
    v_and_b32_dpp v49, v34, v37 row_shl:4 row_mask:0xf bank_mask:0xf bound_ctrl:0
    s_waitcnt vmcnt(0)
    s_nop 0
    v_mfma_f32_16x16x32_bf16 v[40:43], v[164:167], v[48:51], v[40:43]
    s_nop 7
    v_pk_mul_f32 v[40:41], v[40:41], v[56:57] op_sel:[0,1]
    v_pk_mul_f32 v[42:43], v[42:43], v[56:57] op_sel:[0,1]
    ds_write_b128 v58, v[40:43]
    s_cmp_lg_u32 s3, 0
    s_waitcnt lgkmcnt(0)
    s_barrier
    s_cbranch_scc1 L_notw0
    ds_read_b128 v[4:7], v58 offset:1024
    ds_read_b128 v[8:11], v58 offset:2048
    ds_read_b128 v[12:15], v58 offset:3072
    s_cmp_lg_u32 s55, 0
    s_waitcnt lgkmcnt(2)
    v_pk_add_f32 v[4:5], v[4:5], v[40:41]
    v_pk_add_f32 v[6:7], v[6:7], v[42:43]
    s_waitcnt lgkmcnt(0)
    v_pk_add_f32 v[8:9], v[8:9], v[12:13]
    v_pk_add_f32 v[10:11], v[10:11], v[14:15]
    v_pk_add_f32 v[4:5], v[4:5], v[8:9]
    v_pk_add_f32 v[6:7], v[6:7], v[10:11]
    v_bfi_b32 v4, s56, v60, v4
    v_bfi_b32 v5, s56, v61, v5
    v_bfi_b32 v6, s56, v62, v6
    v_bfi_b32 v7, s56, v63, v7
    s_cbranch_scc1 L_pubfar
    buffer_store_dwordx4 v[4:7], v24, s[36:39], s57 offen
    s_endpgm
L_pubfar:
    buffer_store_dwordx4 v[4:7], v24, s[36:39], s57 offen sc1
L_pubdone:
    s_endpgm
L_notw0:
    s_xor_b32 s47, s3, 1
    s_andn2_b32 s46, s2, 20
    s_or_b32 s47, s47, s46
    s_cbranch_scc1 L_end
    v_mov_b32 v50, 82816
    ds_read_b32 v50, v50 offset:12
    s_waitcnt lgkmcnt(0)
    v_cmp_ne_u32 vcc, 0, v50
    s_nop 0
    s_cbranch_vccnz L_end
    s_mov_b32 s40, s4
    s_and_b32 s41, s5, 0xffff
    s_mov_b32 s42, 2304
    s_mov_b32 s43, 0x20000
    s_mov_b32 s44, s24
    s_and_b32 s45, s25, 0xffff
    s_mov_b32 s46, 2304
    s_mov_b32 s47, 0x20000
    s_sub_u32 s62, s3, 1
    s_cmp_eq_u32 s3, 3
    s_cselect_b32 s63, 0, s3
    s_add_u32 s64, s62, s63
    s_sub_u32 s64, 3, s64
    s_mul_i32 s59, s32, 16384
    s_add_u32 s59, s59, 524288
    s_lshl_b32 s53, s62, 10
    s_add_u32 s53, s53, s59
    s_mul_i32 s62, s62, 192
    s_lshl_b32 s55, s63, 10
    s_add_u32 s55, s55, s59
    s_mul_i32 s63, s63, 192
    s_lshl_b32 s58, s64, 10
    s_add_u32 s58, s58, s59
    s_mul_i32 s64, s64, 192
    s_or_b32 s56, s32, s62
    s_cbranch_scc1 L_noepo
    v_mov_b32 v50, s35
    v_mov_b32 v51, 655360
    s_mov_b64 exec, 1
    buffer_store_dword v50, v51, s[36:39], 0 offen sc1
    s_mov_b64 exec, -1
L_noepo:
    s_mul_i32 s56, s32, 1152
    v_mul_u32_u24 v55, 3, v1
    v_add3_u32 v50, v55, s62, 0
    v_mul_u32_u24 v51, 3641, v50
    v_lshrrev_b32 v51, 18, v51
    v_mul_u32_u24 v52, 72, v51
    v_sub_u32 v52, v50, v52
    v_lshl_add_u32 v53, v51, 6, v52
    v_lshl_add_u32 v54, v51, 3, v52
    v_add_u32 v54, 448, v54
    v_cmp_gt_u32 vcc, 64, v52
    s_nop 1
    v_cndmask_b32 v53, v54, v53, vcc
    v_lshlrev_b32 v100, 1, v53
    buffer_load_ushort v28, v100, s[40:43], s56 offen
    v_add3_u32 v50, v55, s62, 1
    v_mul_u32_u24 v51, 3641, v50
    v_lshrrev_b32 v51, 18, v51
    v_mul_u32_u24 v52, 72, v51
    v_sub_u32 v52, v50, v52
    v_lshl_add_u32 v53, v51, 6, v52
    v_lshl_add_u32 v54, v51, 3, v52
    v_add_u32 v54, 448, v54
    v_cmp_gt_u32 vcc, 64, v52
    s_nop 1
    v_cndmask_b32 v53, v54, v53, vcc
    v_lshlrev_b32 v101, 1, v53
    buffer_load_ushort v29, v101, s[40:43], s56 offen
    v_add3_u32 v50, v55, s62, 2
    v_mul_u32_u24 v51, 3641, v50
    v_lshrrev_b32 v51, 18, v51
    v_mul_u32_u24 v52, 72, v51
    v_sub_u32 v52, v50, v52
    v_lshl_add_u32 v53, v51, 6, v52
    v_lshl_add_u32 v54, v51, 3, v52
    v_add_u32 v54, 448, v54
    v_cmp_gt_u32 vcc, 64, v52
    s_nop 1
    v_cndmask_b32 v53, v54, v53, vcc
    v_lshlrev_b32 v102, 1, v53
    buffer_load_ushort v30, v102, s[40:43], s56 offen
    v_add3_u32 v50, v55, s63, 0
    v_mul_u32_u24 v51, 3641, v50
    v_lshrrev_b32 v51, 18, v51
    v_mul_u32_u24 v52, 72, v51
    v_sub_u32 v52, v50, v52
    v_lshl_add_u32 v53, v51, 6, v52
    v_lshl_add_u32 v54, v51, 3, v52
    v_add_u32 v54, 448, v54
    v_cmp_gt_u32 vcc, 64, v52
    s_nop 1
    v_cndmask_b32 v53, v54, v53, vcc
    v_lshlrev_b32 v103, 1, v53
    buffer_load_ushort v31, v103, s[40:43], s56 offen
    v_add3_u32 v50, v55, s63, 1
    v_mul_u32_u24 v51, 3641, v50
    v_lshrrev_b32 v51, 18, v51
    v_mul_u32_u24 v52, 72, v51
    v_sub_u32 v52, v50, v52
    v_lshl_add_u32 v53, v51, 6, v52
    v_lshl_add_u32 v54, v51, 3, v52
    v_add_u32 v54, 448, v54
    v_cmp_gt_u32 vcc, 64, v52
    s_nop 1
    v_cndmask_b32 v53, v54, v53, vcc
    v_lshlrev_b32 v104, 1, v53
    buffer_load_ushort v32, v104, s[40:43], s56 offen
    v_add3_u32 v50, v55, s63, 2
    v_mul_u32_u24 v51, 3641, v50
    v_lshrrev_b32 v51, 18, v51
    v_mul_u32_u24 v52, 72, v51
    v_sub_u32 v52, v50, v52
    v_lshl_add_u32 v53, v51, 6, v52
    v_lshl_add_u32 v54, v51, 3, v52
    v_add_u32 v54, 448, v54
    v_cmp_gt_u32 vcc, 64, v52
    s_nop 1
    v_cndmask_b32 v53, v54, v53, vcc
    v_lshlrev_b32 v105, 1, v53
    buffer_load_ushort v33, v105, s[40:43], s56 offen
    v_add3_u32 v50, v55, s64, 0
    v_mul_u32_u24 v51, 3641, v50
    v_lshrrev_b32 v51, 18, v51
    v_mul_u32_u24 v52, 72, v51
    v_sub_u32 v52, v50, v52
    v_lshl_add_u32 v53, v51, 6, v52
    v_lshl_add_u32 v54, v51, 3, v52
    v_add_u32 v54, 448, v54
    v_cmp_gt_u32 vcc, 64, v52
    s_nop 1
    v_cndmask_b32 v53, v54, v53, vcc
    v_lshlrev_b32 v106, 1, v53
    buffer_load_ushort v34, v106, s[40:43], s56 offen
    v_add3_u32 v50, v55, s64, 1
    v_mul_u32_u24 v51, 3641, v50
    v_lshrrev_b32 v51, 18, v51
    v_mul_u32_u24 v52, 72, v51
    v_sub_u32 v52, v50, v52
    v_lshl_add_u32 v53, v51, 6, v52
    v_lshl_add_u32 v54, v51, 3, v52
    v_add_u32 v54, 448, v54
    v_cmp_gt_u32 vcc, 64, v52
    s_nop 1
    v_cndmask_b32 v53, v54, v53, vcc
    v_lshlrev_b32 v107, 1, v53
    buffer_load_ushort v35, v107, s[40:43], s56 offen
    v_add3_u32 v50, v55, s64, 2
    v_mul_u32_u24 v51, 3641, v50
    v_lshrrev_b32 v51, 18, v51
    v_mul_u32_u24 v52, 72, v51
    v_sub_u32 v52, v50, v52
    v_lshl_add_u32 v53, v51, 6, v52
    v_lshl_add_u32 v54, v51, 3, v52
    v_add_u32 v54, 448, v54
    v_cmp_gt_u32 vcc, 64, v52
    s_nop 1
    v_cndmask_b32 v53, v54, v53, vcc
    v_lshlrev_b32 v108, 1, v53
    buffer_load_ushort v36, v108, s[40:43], s56 offen
    s_barrier
    s_mov_b32 s54, 524288
    s_mov_b32 s57, 0x43000000
    s_mov_b32 s60, 0xffff2800
    s_mov_b32 s61, 0x1ffff
    s_waitcnt vmcnt(0)
    v_lshlrev_b32 v28, 16, v28
    v_lshlrev_b32 v29, 16, v29
    v_lshlrev_b32 v30, 16, v30
    v_lshlrev_b32 v31, 16, v31
    v_lshlrev_b32 v32, 16, v32
    v_lshlrev_b32 v33, 16, v33
    v_lshlrev_b32 v34, 16, v34
    v_lshlrev_b32 v35, 16, v35
    v_lshlrev_b32 v36, 16, v36
L_zspin:
    buffer_load_dwordx4 v[128:131], v3, s[36:39], s53 offen sc1
    buffer_load_dwordx4 v[132:135], v3, s[36:39], s55 offen sc1
    buffer_load_dwordx4 v[136:139], v3, s[36:39], s58 offen sc1
    s_waitcnt vmcnt(0)
    v_min3_f32 v50, v131, v135, v139
    v_cmp_neq_f32 vcc, s57, v50
    s_nop 0
    s_cbranch_vccz L_zok
    s_sub_u32 s54, s54, 1
    s_cmp_lg_u32 s54, 0
    s_cbranch_scc1 L_zspin
L_zok:
    v_cvt_pk_bf16_f32 v40, 0, v128
    v_cvt_pk_bf16_f32 v41, 0, v129
    v_cvt_pk_bf16_f32 v42, 0, v130
    v_cvt_pk_bf16_f32 v43, 0, v132
    v_cvt_pk_bf16_f32 v44, 0, v133
    v_cvt_pk_bf16_f32 v45, 0, v134
    v_cvt_pk_bf16_f32 v46, 0, v136
    v_cvt_pk_bf16_f32 v47, 0, v137
    v_cvt_pk_bf16_f32 v48, 0, v138
    v_pk_add_f32 v[40:41], v[40:41], v[28:29]
    v_pk_add_f32 v[42:43], v[42:43], v[30:31]
    v_pk_add_f32 v[44:45], v[44:45], v[32:33]
    v_pk_add_f32 v[46:47], v[46:47], v[34:35]
    v_add_f32 v48, v48, v36
    v_cvt_pk_bf16_f32 v40, 0, v40
    v_cvt_pk_bf16_f32 v41, 0, v41
    v_cvt_pk_bf16_f32 v42, 0, v42
    v_cvt_pk_bf16_f32 v43, 0, v43
    v_cvt_pk_bf16_f32 v44, 0, v44
    v_cvt_pk_bf16_f32 v45, 0, v45
    v_cvt_pk_bf16_f32 v46, 0, v46
    v_cvt_pk_bf16_f32 v47, 0, v47
    v_cvt_pk_bf16_f32 v48, 0, v48
    v_pk_add_f32 v[50:51], v[40:41], v[42:43]
    v_pk_mul_f32 v[52:53], v[40:41], v[40:41]
    v_pk_fma_f32 v[52:53], v[42:43], v[42:43], v[52:53]
    v_pk_add_f32 v[50:51], v[50:51], v[44:45]
    v_pk_fma_f32 v[52:53], v[44:45], v[44:45], v[52:53]
    v_pk_add_f32 v[50:51], v[50:51], v[46:47]
    v_pk_fma_f32 v[52:53], v[46:47], v[46:47], v[52:53]
    v_add_f32 v50, v50, v48
    v_fmac_f32 v52, v48, v48
    v_add_f32 v50, v50, v51
    v_add_f32 v52, v52, v53
    s_nop 0
    v_add_f32_dpp v50, v50, v50 quad_perm:[1,0,3,2] row_mask:0xf bank_mask:0xf
    v_add_f32_dpp v52, v52, v52 quad_perm:[1,0,3,2] row_mask:0xf bank_mask:0xf
    s_nop 0
    v_add_f32_dpp v50, v50, v50 quad_perm:[2,3,0,1] row_mask:0xf bank_mask:0xf
    v_add_f32_dpp v52, v52, v52 quad_perm:[2,3,0,1] row_mask:0xf bank_mask:0xf
    s_nop 0
    v_add_f32_dpp v50, v50, v50 row_half_mirror row_mask:0xf bank_mask:0xf
    v_add_f32_dpp v52, v52, v52 row_half_mirror row_mask:0xf bank_mask:0xf
    s_nop 0
    v_add_f32_dpp v50, v50, v50 row_mirror row_mask:0xf bank_mask:0xf
    v_add_f32_dpp v52, v52, v52 row_mirror row_mask:0xf bank_mask:0xf
    v_mov_b32 v54, v50
    v_mov_b32 v55, v52
    s_nop 0
    v_permlane16_swap_b32 v50, v54
    v_permlane16_swap_b32 v52, v55
    v_add_f32 v50, v50, v54
    v_add_f32 v52, v52, v55
    v_mov_b32 v54, v50
    v_mov_b32 v55, v52
    s_nop 0
    v_permlane32_swap_b32 v50, v54
    v_permlane32_swap_b32 v52, v55
    v_add_f32 v50, v50, v54
    v_add_f32 v52, v52, v55
    v_mul_f32 v50, 0x3ae38e39, v50
    v_mul_f32 v52, 0x3ae38e39, v52
    v_fma_f32 v52, -v50, v50, v52
    v_cvt_pk_bf16_f32 v50, 0, -v50
    v_max_f32 v52, 0, v52
    v_cvt_pk_bf16_f32 v52, 0, v52
    v_pk_add_f32 v[16:17], v[40:41], v[50:51] op_sel_hi:[1,0]
    v_add_f32 v52, 0x3727c5ac, v52
    v_pk_add_f32 v[18:19], v[42:43], v[50:51] op_sel_hi:[1,0]
    v_cvt_pk_bf16_f32 v52, 0, v52
    v_pk_add_f32 v[20:21], v[44:45], v[50:51] op_sel_hi:[1,0]
    v_sqrt_f32 v52, v52
    v_pk_add_f32 v[22:23], v[46:47], v[50:51] op_sel_hi:[1,0]
    v_cvt_pk_bf16_f32 v52, 0, v52
    v_add_f32 v24, v48, v50
    v_rcp_f32 v52, v52
    v_cvt_pk_bf16_f32 v16, 0, v16
    v_cvt_pk_bf16_f32 v17, 0, v17
    v_cvt_pk_bf16_f32 v18, 0, v18
    v_cvt_pk_bf16_f32 v19, 0, v19
    v_cvt_pk_bf16_f32 v20, 0, v20
    v_cvt_pk_bf16_f32 v21, 0, v21
    v_cvt_pk_bf16_f32 v22, 0, v22
    v_cvt_pk_bf16_f32 v23, 0, v23
    v_cvt_pk_bf16_f32 v24, 0, v24
    v_pk_mul_f32 v[16:17], v[16:17], v[52:53] op_sel_hi:[1,0]
    v_pk_mul_f32 v[18:19], v[18:19], v[52:53] op_sel_hi:[1,0]
    v_pk_mul_f32 v[20:21], v[20:21], v[52:53] op_sel_hi:[1,0]
    v_pk_mul_f32 v[22:23], v[22:23], v[52:53] op_sel_hi:[1,0]
    v_mul_f32 v24, v24, v52
    v_cvt_pk_bf16_f32 v16, 0, v16
    v_cvt_pk_bf16_f32 v17, 0, v17
    v_cvt_pk_bf16_f32 v18, 0, v18
    v_cvt_pk_bf16_f32 v19, 0, v19
    v_cvt_pk_bf16_f32 v20, 0, v20
    v_cvt_pk_bf16_f32 v21, 0, v21
    v_cvt_pk_bf16_f32 v22, 0, v22
    v_cvt_pk_bf16_f32 v23, 0, v23
    v_cvt_pk_bf16_f32 v24, 0, v24
    v_pk_add_f32 v[50:51], v[16:17], v[18:19]
    v_pk_mul_f32 v[52:53], v[16:17], v[16:17]
    v_pk_fma_f32 v[52:53], v[18:19], v[18:19], v[52:53]
    v_pk_add_f32 v[50:51], v[50:51], v[20:21]
    v_pk_fma_f32 v[52:53], v[20:21], v[20:21], v[52:53]
    v_pk_add_f32 v[50:51], v[50:51], v[22:23]
    v_pk_fma_f32 v[52:53], v[22:23], v[22:23], v[52:53]
    v_add_f32 v50, v50, v24
    v_fmac_f32 v52, v24, v24
    v_add_f32 v50, v50, v51
    v_add_f32 v52, v52, v53
    s_nop 0
    v_add_f32_dpp v50, v50, v50 quad_perm:[1,0,3,2] row_mask:0xf bank_mask:0xf
    v_add_f32_dpp v52, v52, v52 quad_perm:[1,0,3,2] row_mask:0xf bank_mask:0xf
    s_nop 0
    v_add_f32_dpp v50, v50, v50 quad_perm:[2,3,0,1] row_mask:0xf bank_mask:0xf
    v_add_f32_dpp v52, v52, v52 quad_perm:[2,3,0,1] row_mask:0xf bank_mask:0xf
    s_nop 0
    v_add_f32_dpp v50, v50, v50 row_half_mirror row_mask:0xf bank_mask:0xf
    v_add_f32_dpp v52, v52, v52 row_half_mirror row_mask:0xf bank_mask:0xf
    s_nop 0
    v_add_f32_dpp v50, v50, v50 row_mirror row_mask:0xf bank_mask:0xf
    v_add_f32_dpp v52, v52, v52 row_mirror row_mask:0xf bank_mask:0xf
    v_mov_b32 v54, v50
    v_mov_b32 v55, v52
    s_nop 0
    v_permlane16_swap_b32 v50, v54
    v_permlane16_swap_b32 v52, v55
    v_add_f32 v50, v50, v54
    v_add_f32 v52, v52, v55
    v_mov_b32 v54, v50
    v_mov_b32 v55, v52
    s_nop 0
    v_permlane32_swap_b32 v50, v54
    v_permlane32_swap_b32 v52, v55
    v_add_f32 v50, v50, v54
    v_add_f32 v52, v52, v55
    v_mul_f32 v50, 0x3ae38e39, v50
    v_mul_f32 v52, 0x3ae38e39, v52
    v_fma_f32 v52, -v50, v50, v52
    v_cvt_pk_bf16_f32 v50, 0, -v50
    v_max_f32 v52, 0, v52
    v_cvt_pk_bf16_f32 v52, 0, v52
    v_pk_add_f32 v[16:17], v[16:17], v[50:51] op_sel_hi:[1,0]
    v_add_f32 v52, 0x3727c5ac, v52
    v_pk_add_f32 v[18:19], v[18:19], v[50:51] op_sel_hi:[1,0]
    v_cvt_pk_bf16_f32 v52, 0, v52
    v_pk_add_f32 v[20:21], v[20:21], v[50:51] op_sel_hi:[1,0]
    v_sqrt_f32 v52, v52
    v_pk_add_f32 v[22:23], v[22:23], v[50:51] op_sel_hi:[1,0]
    v_cvt_pk_bf16_f32 v52, 0, v52
    v_add_f32 v24, v24, v50
    v_rcp_f32 v52, v52
    v_cvt_pk_bf16_f32 v16, 0, v16
    v_cvt_pk_bf16_f32 v17, 0, v17
    v_cvt_pk_bf16_f32 v18, 0, v18
    v_cvt_pk_bf16_f32 v19, 0, v19
    v_cvt_pk_bf16_f32 v20, 0, v20
    v_cvt_pk_bf16_f32 v21, 0, v21
    v_cvt_pk_bf16_f32 v22, 0, v22
    v_cvt_pk_bf16_f32 v23, 0, v23
    v_cvt_pk_bf16_f32 v24, 0, v24
    v_pk_mul_f32 v[16:17], v[16:17], v[52:53] op_sel_hi:[1,0]
    v_pk_mul_f32 v[18:19], v[18:19], v[52:53] op_sel_hi:[1,0]
    v_pk_mul_f32 v[20:21], v[20:21], v[52:53] op_sel_hi:[1,0]
    v_pk_mul_f32 v[22:23], v[22:23], v[52:53] op_sel_hi:[1,0]
    v_mul_f32 v24, v24, v52
    v_cvt_pk_bf16_f32 v16, v16, 0
    v_cvt_pk_bf16_f32 v17, v17, 0
    v_cvt_pk_bf16_f32 v18, v18, 0
    v_cvt_pk_bf16_f32 v19, v19, 0
    v_cvt_pk_bf16_f32 v20, v20, 0
    v_cvt_pk_bf16_f32 v21, v21, 0
    v_cvt_pk_bf16_f32 v22, v22, 0
    v_cvt_pk_bf16_f32 v23, v23, 0
    v_cvt_pk_bf16_f32 v24, v24, 0
    v_lshl_add_u32 v28, v16, 2, s60
    ds_read_b32 v6, v28
    v_lshl_add_u32 v29, v17, 2, s60
    ds_read_b32 v7, v29
    v_lshl_add_u32 v30, v18, 2, s60
    ds_read_b32 v8, v30
    v_lshl_add_u32 v31, v19, 2, s60
    ds_read_b32 v9, v31
    v_lshl_add_u32 v32, v20, 2, s60
    ds_read_b32 v10, v32
    v_lshl_add_u32 v33, v21, 2, s60
    ds_read_b32 v11, v33
    v_lshl_add_u32 v34, v22, 2, s60
    ds_read_b32 v12, v34
    v_lshl_add_u32 v35, v23, 2, s60
    ds_read_b32 v13, v35
    v_lshl_add_u32 v36, v24, 2, s60
    ds_read_b32 v14, v36
    v_and_b32 v28, s61, v28
    v_and_b32 v29, s61, v29
    v_and_b32 v30, s61, v30
    v_and_b32 v31, s61, v31
    v_and_b32 v32, s61, v32
    v_and_b32 v33, s61, v33
    v_and_b32 v34, s61, v34
    v_and_b32 v35, s61, v35
    v_and_b32 v36, s61, v36
    v_max3_u32 v50, v28, v29, v30
    v_max3_u32 v50, v50, v31, v32
    v_max3_u32 v50, v50, v33, v34
    v_max3_u32 v50, v50, v35, v36
    v_cmp_le_u32 vcc, 12288, v50
    s_waitcnt lgkmcnt(0)
    s_cbranch_vccnz L_fallback
L_fout:
    v_pk_add_f32 v[40:41], v[40:41], v[6:7]
    v_pk_add_f32 v[42:43], v[42:43], v[8:9]
    v_pk_add_f32 v[44:45], v[44:45], v[10:11]
    v_pk_add_f32 v[46:47], v[46:47], v[12:13]
    v_add_f32 v48, v48, v14
    v_cvt_pk_bf16_f32 v40, v40, v41
    buffer_store_short v40, v100, s[44:47], s56 offen
    buffer_store_short_d16_hi v40, v101, s[44:47], s56 offen
    v_cvt_pk_bf16_f32 v42, v42, v43
    buffer_store_short v42, v102, s[44:47], s56 offen
    buffer_store_short_d16_hi v42, v103, s[44:47], s56 offen
    v_cvt_pk_bf16_f32 v44, v44, v45
    buffer_store_short v44, v104, s[44:47], s56 offen
    buffer_store_short_d16_hi v44, v105, s[44:47], s56 offen
    v_cvt_pk_bf16_f32 v46, v46, v47
    buffer_store_short v46, v106, s[44:47], s56 offen
    buffer_store_short_d16_hi v46, v107, s[44:47], s56 offen
    v_cvt_pk_bf16_f32 v48, v48, v48
    buffer_store_short v48, v108, s[44:47], s56 offen
    s_endpgm
L_fallback:
    s_nop 7
    s_cmp_eq_u32 s61, -1
    s_cbranch_scc1 L_hready
    s_mov_b32 s36, s16
    s_and_b32 s37, s17, 0xffff
    s_mov_b32 s38, 9216
    s_mov_b32 s39, 0x20000
    s_mov_b32 s40, s18
    s_and_b32 s41, s19, 0xffff
    s_mov_b32 s42, 9216
    s_mov_b32 s43, 0x20000
    s_mov_b32 s64, s20
    s_and_b32 s65, s21, 0xffff
    s_mov_b32 s66, 9216
    s_mov_b32 s67, 0x20000
    s_load_dword s62, s[22:23], 0
    v_mov_b32 v58, 0xc0135761
    s_mov_b32 s61, 0xbdd2d3e8
    s_waitcnt lgkmcnt(0)
    s_lshl_b32 s62, s62, 16
    v_cmp_le_u32 vcc, 12288, v28
    s_nop 0
    s_mov_b64 s[58:59], vcc
L_fb0:
    s_nop 7
    s_cmp_eq_u64 s[58:59], 0
    s_cbranch_scc1 L_fbn0
    s_ff1_i32_b64 s63, s[58:59]
    s_bitset0_b64 s[58:59], s63
    s_nop 3
    v_readlane_b32 s60, v16, s63
    s_nop 0
    s_lshl_b32 s60, s60, 16
    s_getpc_b64 s[68:69]
    s_add_u32 s68, s68, 12
    s_addc_u32 s69, s69, 0
    s_branch L_fbeval
L_fbr0:
    s_nop 7
    s_mov_b32 m0, s63
    v_readfirstlane_b32 s60, v50
    s_nop 4
    v_writelane_b32 v6, s60, m0
    s_branch L_fb0
L_fbn0:
    s_nop 7
    v_cmp_le_u32 vcc, 12288, v29
    s_nop 0
    s_mov_b64 s[58:59], vcc
L_fb1:
    s_nop 7
    s_cmp_eq_u64 s[58:59], 0
    s_cbranch_scc1 L_fbn1
    s_ff1_i32_b64 s63, s[58:59]
    s_bitset0_b64 s[58:59], s63
    s_nop 3
    v_readlane_b32 s60, v17, s63
    s_nop 0
    s_lshl_b32 s60, s60, 16
    s_getpc_b64 s[68:69]
    s_add_u32 s68, s68, 12
    s_addc_u32 s69, s69, 0
    s_branch L_fbeval
L_fbr1:
    s_nop 7
    s_mov_b32 m0, s63
    v_readfirstlane_b32 s60, v50
    s_nop 4
    v_writelane_b32 v7, s60, m0
    s_branch L_fb1
L_fbn1:
    s_nop 7
    v_cmp_le_u32 vcc, 12288, v30
    s_nop 0
    s_mov_b64 s[58:59], vcc
L_fb2:
    s_nop 7
    s_cmp_eq_u64 s[58:59], 0
    s_cbranch_scc1 L_fbn2
    s_ff1_i32_b64 s63, s[58:59]
    s_bitset0_b64 s[58:59], s63
    s_nop 3
    v_readlane_b32 s60, v18, s63
    s_nop 0
    s_lshl_b32 s60, s60, 16
    s_getpc_b64 s[68:69]
    s_add_u32 s68, s68, 12
    s_addc_u32 s69, s69, 0
    s_branch L_fbeval
L_fbr2:
    s_nop 7
    s_mov_b32 m0, s63
    v_readfirstlane_b32 s60, v50
    s_nop 4
    v_writelane_b32 v8, s60, m0
    s_branch L_fb2
L_fbn2:
    s_nop 7
    v_cmp_le_u32 vcc, 12288, v31
    s_nop 0
    s_mov_b64 s[58:59], vcc
L_fb3:
    s_nop 7
    s_cmp_eq_u64 s[58:59], 0
    s_cbranch_scc1 L_fbn3
    s_ff1_i32_b64 s63, s[58:59]
    s_bitset0_b64 s[58:59], s63
    s_nop 3
    v_readlane_b32 s60, v19, s63
    s_nop 0
    s_lshl_b32 s60, s60, 16
    s_getpc_b64 s[68:69]
    s_add_u32 s68, s68, 12
    s_addc_u32 s69, s69, 0
    s_branch L_fbeval
L_fbr3:
    s_nop 7
    s_mov_b32 m0, s63
    v_readfirstlane_b32 s60, v50
    s_nop 4
    v_writelane_b32 v9, s60, m0
    s_branch L_fb3
L_fbn3:
    s_nop 7
    v_cmp_le_u32 vcc, 12288, v32
    s_nop 0
    s_mov_b64 s[58:59], vcc
L_fb4:
    s_nop 7
    s_cmp_eq_u64 s[58:59], 0
    s_cbranch_scc1 L_fbn4
    s_ff1_i32_b64 s63, s[58:59]
    s_bitset0_b64 s[58:59], s63
    s_nop 3
    v_readlane_b32 s60, v20, s63
    s_nop 0
    s_lshl_b32 s60, s60, 16
    s_getpc_b64 s[68:69]
    s_add_u32 s68, s68, 12
    s_addc_u32 s69, s69, 0
    s_branch L_fbeval
L_fbr4:
    s_nop 7
    s_mov_b32 m0, s63
    v_readfirstlane_b32 s60, v50
    s_nop 4
    v_writelane_b32 v10, s60, m0
    s_branch L_fb4
L_fbn4:
    s_nop 7
    v_cmp_le_u32 vcc, 12288, v33
    s_nop 0
    s_mov_b64 s[58:59], vcc
L_fb5:
    s_nop 7
    s_cmp_eq_u64 s[58:59], 0
    s_cbranch_scc1 L_fbn5
    s_ff1_i32_b64 s63, s[58:59]
    s_bitset0_b64 s[58:59], s63
    s_nop 3
    v_readlane_b32 s60, v21, s63
    s_nop 0
    s_lshl_b32 s60, s60, 16
    s_getpc_b64 s[68:69]
    s_add_u32 s68, s68, 12
    s_addc_u32 s69, s69, 0
    s_branch L_fbeval
L_fbr5:
    s_nop 7
    s_mov_b32 m0, s63
    v_readfirstlane_b32 s60, v50
    s_nop 4
    v_writelane_b32 v11, s60, m0
    s_branch L_fb5
L_fbn5:
    s_nop 7
    v_cmp_le_u32 vcc, 12288, v34
    s_nop 0
    s_mov_b64 s[58:59], vcc
L_fb6:
    s_nop 7
    s_cmp_eq_u64 s[58:59], 0
    s_cbranch_scc1 L_fbn6
    s_ff1_i32_b64 s63, s[58:59]
    s_bitset0_b64 s[58:59], s63
    s_nop 3
    v_readlane_b32 s60, v22, s63
    s_nop 0
    s_lshl_b32 s60, s60, 16
    s_getpc_b64 s[68:69]
    s_add_u32 s68, s68, 12
    s_addc_u32 s69, s69, 0
    s_branch L_fbeval
L_fbr6:
    s_nop 7
    s_mov_b32 m0, s63
    v_readfirstlane_b32 s60, v50
    s_nop 4
    v_writelane_b32 v12, s60, m0
    s_branch L_fb6
L_fbn6:
    s_nop 7
    v_cmp_le_u32 vcc, 12288, v35
    s_nop 0
    s_mov_b64 s[58:59], vcc
L_fb7:
    s_nop 7
    s_cmp_eq_u64 s[58:59], 0
    s_cbranch_scc1 L_fbn7
    s_ff1_i32_b64 s63, s[58:59]
    s_bitset0_b64 s[58:59], s63
    s_nop 3
    v_readlane_b32 s60, v23, s63
    s_nop 0
    s_lshl_b32 s60, s60, 16
    s_getpc_b64 s[68:69]
    s_add_u32 s68, s68, 12
    s_addc_u32 s69, s69, 0
    s_branch L_fbeval
L_fbr7:
    s_nop 7
    s_mov_b32 m0, s63
    v_readfirstlane_b32 s60, v50
    s_nop 4
    v_writelane_b32 v13, s60, m0
    s_branch L_fb7
L_fbn7:
    s_nop 7
    v_cmp_le_u32 vcc, 12288, v36
    s_nop 0
    s_mov_b64 s[58:59], vcc
L_fb8:
    s_nop 7
    s_cmp_eq_u64 s[58:59], 0
    s_cbranch_scc1 L_fbn8
    s_ff1_i32_b64 s63, s[58:59]
    s_bitset0_b64 s[58:59], s63
    s_nop 3
    v_readlane_b32 s60, v24, s63
    s_nop 0
    s_lshl_b32 s60, s60, 16
    s_getpc_b64 s[68:69]
    s_add_u32 s68, s68, 12
    s_addc_u32 s69, s69, 0
    s_branch L_fbeval
L_fbr8:
    s_nop 7
    s_mov_b32 m0, s63
    v_readfirstlane_b32 s60, v50
    s_nop 4
    v_writelane_b32 v14, s60, m0
    s_branch L_fb8
L_fbn8:
    s_nop 7
    s_nop 4
    s_branch L_fout
L_fbeval:
    s_nop 7
    v_mov_b32 v50, 0
    s_mov_b32 s55, 0
L_fbl:
    s_nop 7
    buffer_load_dwordx4 v[64:67], v3, s[36:39], s55 offen
    buffer_load_dwordx4 v[68:71], v3, s[40:43], s55 offen
    buffer_load_dwordx4 v[72:75], v3, s[64:67], s55 offen
    s_waitcnt vmcnt(0)
    v_lshlrev_b32 v76, 16, v64
    v_and_b32 v77, 0xffff0000, v64
    v_mul_f32 v76, s60, v76
    v_mul_f32 v77, s60, v77
    v_cvt_pk_bf16_f32 v76, 0, v76
    v_cvt_pk_bf16_f32 v77, 0, v77
    v_lshlrev_b32 v78, 16, v68
    v_and_b32 v79, 0xffff0000, v68
    v_add_f32 v76, v76, v78
    v_add_f32 v77, v77, v79
    v_lshlrev_b32 v80, 16, v72
    v_and_b32 v81, 0xffff0000, v72
    v_cvt_pk_bf16_f32 v76, 0, v76
    v_cvt_pk_bf16_f32 v77, 0, v77
    v_mul_f32 v78, v76, v76
    v_mul_f32 v79, v77, v77
    v_fma_f32 v78, v78, s61, v58
    v_fma_f32 v79, v79, s61, v58
    v_mul_f32 v78, v78, v76
    v_mul_f32 v79, v79, v77
    v_exp_f32 v78, v78
    v_exp_f32 v79, v79
    v_add_f32 v78, 1.0, v78
    v_add_f32 v79, 1.0, v79
    v_rcp_f32 v78, v78
    v_rcp_f32 v79, v79
    v_mul_f32 v76, v76, v78
    v_mul_f32 v77, v77, v79
    v_cvt_pk_bf16_f32 v76, 0, v76
    v_cvt_pk_bf16_f32 v77, 0, v77
    v_fmac_f32 v50, v76, v80
    v_fmac_f32 v50, v77, v81
    v_lshlrev_b32 v76, 16, v65
    v_and_b32 v77, 0xffff0000, v65
    v_mul_f32 v76, s60, v76
    v_mul_f32 v77, s60, v77
    v_cvt_pk_bf16_f32 v76, 0, v76
    v_cvt_pk_bf16_f32 v77, 0, v77
    v_lshlrev_b32 v78, 16, v69
    v_and_b32 v79, 0xffff0000, v69
    v_add_f32 v76, v76, v78
    v_add_f32 v77, v77, v79
    v_lshlrev_b32 v80, 16, v73
    v_and_b32 v81, 0xffff0000, v73
    v_cvt_pk_bf16_f32 v76, 0, v76
    v_cvt_pk_bf16_f32 v77, 0, v77
    v_mul_f32 v78, v76, v76
    v_mul_f32 v79, v77, v77
    v_fma_f32 v78, v78, s61, v58
    v_fma_f32 v79, v79, s61, v58
    v_mul_f32 v78, v78, v76
    v_mul_f32 v79, v79, v77
    v_exp_f32 v78, v78
    v_exp_f32 v79, v79
    v_add_f32 v78, 1.0, v78
    v_add_f32 v79, 1.0, v79
    v_rcp_f32 v78, v78
    v_rcp_f32 v79, v79
    v_mul_f32 v76, v76, v78
    v_mul_f32 v77, v77, v79
    v_cvt_pk_bf16_f32 v76, 0, v76
    v_cvt_pk_bf16_f32 v77, 0, v77
    v_fmac_f32 v50, v76, v80
    v_fmac_f32 v50, v77, v81
    v_lshlrev_b32 v76, 16, v66
    v_and_b32 v77, 0xffff0000, v66
    v_mul_f32 v76, s60, v76
    v_mul_f32 v77, s60, v77
    v_cvt_pk_bf16_f32 v76, 0, v76
    v_cvt_pk_bf16_f32 v77, 0, v77
    v_lshlrev_b32 v78, 16, v70
    v_and_b32 v79, 0xffff0000, v70
    v_add_f32 v76, v76, v78
    v_add_f32 v77, v77, v79
    v_lshlrev_b32 v80, 16, v74
    v_and_b32 v81, 0xffff0000, v74
    v_cvt_pk_bf16_f32 v76, 0, v76
    v_cvt_pk_bf16_f32 v77, 0, v77
    v_mul_f32 v78, v76, v76
    v_mul_f32 v79, v77, v77
    v_fma_f32 v78, v78, s61, v58
    v_fma_f32 v79, v79, s61, v58
    v_mul_f32 v78, v78, v76
    v_mul_f32 v79, v79, v77
    v_exp_f32 v78, v78
    v_exp_f32 v79, v79
    v_add_f32 v78, 1.0, v78
    v_add_f32 v79, 1.0, v79
    v_rcp_f32 v78, v78
    v_rcp_f32 v79, v79
    v_mul_f32 v76, v76, v78
    v_mul_f32 v77, v77, v79
    v_cvt_pk_bf16_f32 v76, 0, v76
    v_cvt_pk_bf16_f32 v77, 0, v77
    v_fmac_f32 v50, v76, v80
    v_fmac_f32 v50, v77, v81
    v_lshlrev_b32 v76, 16, v67
    v_and_b32 v77, 0xffff0000, v67
    v_mul_f32 v76, s60, v76
    v_mul_f32 v77, s60, v77
    v_cvt_pk_bf16_f32 v76, 0, v76
    v_cvt_pk_bf16_f32 v77, 0, v77
    v_lshlrev_b32 v78, 16, v71
    v_and_b32 v79, 0xffff0000, v71
    v_add_f32 v76, v76, v78
    v_add_f32 v77, v77, v79
    v_lshlrev_b32 v80, 16, v75
    v_and_b32 v81, 0xffff0000, v75
    v_cvt_pk_bf16_f32 v76, 0, v76
    v_cvt_pk_bf16_f32 v77, 0, v77
    v_mul_f32 v78, v76, v76
    v_mul_f32 v79, v77, v77
    v_fma_f32 v78, v78, s61, v58
    v_fma_f32 v79, v79, s61, v58
    v_mul_f32 v78, v78, v76
    v_mul_f32 v79, v79, v77
    v_exp_f32 v78, v78
    v_exp_f32 v79, v79
    v_add_f32 v78, 1.0, v78
    v_add_f32 v79, 1.0, v79
    v_rcp_f32 v78, v78
    v_rcp_f32 v79, v79
    v_mul_f32 v76, v76, v78
    v_mul_f32 v77, v77, v79
    v_cvt_pk_bf16_f32 v76, 0, v76
    v_cvt_pk_bf16_f32 v77, 0, v77
    v_fmac_f32 v50, v76, v80
    v_fmac_f32 v50, v77, v81
    s_add_u32 s55, s55, 1024
    s_cmp_lt_u32 s55, 9216
    s_cbranch_scc1 L_fbl
    v_add_f32_dpp v50, v50, v50 quad_perm:[1,0,3,2] row_mask:0xf bank_mask:0xf
    s_nop 1
    v_add_f32_dpp v50, v50, v50 quad_perm:[2,3,0,1] row_mask:0xf bank_mask:0xf
    s_nop 1
    v_add_f32_dpp v50, v50, v50 row_half_mirror row_mask:0xf bank_mask:0xf
    s_nop 1
    v_add_f32_dpp v50, v50, v50 row_mirror row_mask:0xf bank_mask:0xf
    v_mov_b32 v51, v50
    s_nop 1
    v_permlane16_swap_b32 v50, v51
    v_add_f32 v50, v50, v51
    v_mov_b32 v51, v50
    s_nop 1
    v_permlane32_swap_b32 v50, v51
    v_add_f32 v50, v50, v51
    v_cvt_pk_bf16_f32 v50, 0, v50
    v_add_f32 v50, s62, v50
    v_cvt_pk_bf16_f32 v50, 0, v50
    s_setpc_b64 s[68:69]
L_helper:
    s_sub_u32 s3, s3, 4
    v_lshlrev_b32 v3, 4, v1
    v_lshlrev_b32 v2, 2, v1
    s_cmp_lg_u32 s3, 1
    s_cbranch_scc1 L_hnoinit
    v_mov_b32 v8, -1
    v_add_u32 v9, 82432, v2
    v_mov_b32 v10, 0
    v_add_u32 v11, 82560, v2
    v_add_u32 v12, 82816, v2
    ds_write_b32 v11, v10
    s_mov_b32 exec_hi, 0
    ds_write_b32 v9, v8
    s_mov_b32 exec_lo, 0xff
    ds_write_b32 v12, v8
    s_mov_b64 exec, -1
L_hnoinit:
    s_lshl_b32 s34, s33, 4
    s_lshl_b32 s40, s32, 3
    s_add_u32 s34, s34, s40
    s_add_u32 s34, s34, s31
    s_waitcnt lgkmcnt(0)
    s_load_dword s35, s[28:29], 655360
    s_mov_b32 s36, s28
    s_and_b32 s37, s29, 0xffff
    s_mov_b32 s38, 1048576
    s_mov_b32 s39, 0x20000
    s_cmp_lg_u32 s3, 0
    s_cbranch_scc1 L_hother
    s_setprio 3
    s_mov_b32 s44, s4
    s_and_b32 s45, s5, 0xffff
    s_mov_b32 s46, 2304
    s_mov_b32 s47, 0x20000
    v_lshrrev_b32 v8, 5, v1
    v_mul_u32_u24 v8, 1152, v8
    v_and_b32 v9, 31, v1
    v_lshl_add_u32 v8, v9, 2, v8
    buffer_load_dword v20, v8, s[44:47], 0 offen offset:0
    buffer_load_dword v22, v8, s[44:47], 0 offen offset:128
    buffer_load_dword v24, v8, s[44:47], 0 offen offset:256
    buffer_load_dword v26, v8, s[44:47], 0 offen offset:384
    buffer_load_dword v28, v8, s[44:47], 0 offen offset:512
    buffer_load_dword v30, v8, s[44:47], 0 offen offset:640
    buffer_load_dword v32, v8, s[44:47], 0 offen offset:768
    buffer_load_dword v34, v8, s[44:47], 0 offen offset:896
    buffer_load_dword v36, v8, s[44:47], 0 offen offset:1024
    s_barrier
    v_add_u32 v12, 83200, v8
    v_lshrrev_b32 v9, 4, v1
    v_and_b32 v13, 15, v1
    v_mov_b32 v15, 82816
    s_bfe_u32 s53, s34, 0x20002
    s_mul_i32 s53, s53, 288
    s_add_u32 s53, s53, 83200
    v_and_b32 v11, 1, v1
    v_mul_u32_u24 v11, 1152, v11
    v_add_u32 v11, s53, v11
    v_lshl_add_u32 v17, v9, 3, v11
    v_lshl_add_u32 v11, v9, 4, v11
    v_lshrrev_b32 v10, 2, v13
    v_lshlrev_b32 v10, 7, v10
    v_and_b32 v18, 3, v1
    v_lshl_add_u32 v10, v18, 3, v10
    v_add_u32 v10, 110592, v10
    v_lshl_add_u32 v18, v9, 9, v10
    v_lshl_add_u32 v10, v9, 10, v10
    v_and_b32 v16, 1, v9
    v_cmp_ne_u32 s[58:59], 0, v16
    v_lshlrev_b32 v16, 12, v16
    v_lshl_add_u32 v16, v13, 4, v16
    v_lshlrev_b32 v14, 8, v1
    s_lshl_b32 s56, s33, 13
    s_and_b32 s52, s34, 15
    s_lshl_b32 s52, s52, 8
    s_add_u32 s52, s52, s56
    s_lshl_b32 s53, s32, 12
    s_add_u32 s56, s56, s53
    s_getreg_b32 s60, hwreg(HW_REG_XCC_ID)
    s_and_b32 s60, s60, 7
    v_lshlrev_b32 v19, 7, v9
    v_lshl_add_u32 v19, v13, 1, v19
    v_add_u32 v19, 81920, v19
    s_waitcnt vmcnt(0) lgkmcnt(0)
    s_mul_i32 s35, s35, 1664525
    s_add_u32 s35, s35, 1013904223
    v_and_b32 v21, 0xffff0000, v20
    v_lshlrev_b32 v20, 16, v20
    v_and_b32 v23, 0xffff0000, v22
    v_lshlrev_b32 v22, 16, v22
    v_and_b32 v25, 0xffff0000, v24
    v_lshlrev_b32 v24, 16, v24
    v_and_b32 v27, 0xffff0000, v26
    v_lshlrev_b32 v26, 16, v26
    v_and_b32 v29, 0xffff0000, v28
    v_lshlrev_b32 v28, 16, v28
    v_and_b32 v31, 0xffff0000, v30
    v_lshlrev_b32 v30, 16, v30
    v_and_b32 v33, 0xffff0000, v32
    v_lshlrev_b32 v32, 16, v32
    v_and_b32 v35, 0xffff0000, v34
    v_lshlrev_b32 v34, 16, v34
    v_and_b32 v37, 0xffff0000, v36
    v_lshlrev_b32 v36, 16, v36
    v_pk_add_f32 v[40:41], v[20:21], v[22:23]
    v_pk_mul_f32 v[42:43], v[20:21], v[20:21]
    v_pk_fma_f32 v[42:43], v[22:23], v[22:23], v[42:43]
    v_pk_add_f32 v[40:41], v[40:41], v[24:25]
    v_pk_fma_f32 v[42:43], v[24:25], v[24:25], v[42:43]
    v_pk_add_f32 v[40:41], v[40:41], v[26:27]
    v_pk_fma_f32 v[42:43], v[26:27], v[26:27], v[42:43]
    v_pk_add_f32 v[40:41], v[40:41], v[28:29]
    v_pk_fma_f32 v[42:43], v[28:29], v[28:29], v[42:43]
    v_pk_add_f32 v[40:41], v[40:41], v[30:31]
    v_pk_fma_f32 v[42:43], v[30:31], v[30:31], v[42:43]
    v_pk_add_f32 v[40:41], v[40:41], v[32:33]
    v_pk_fma_f32 v[42:43], v[32:33], v[32:33], v[42:43]
    v_pk_add_f32 v[40:41], v[40:41], v[34:35]
    v_pk_fma_f32 v[42:43], v[34:35], v[34:35], v[42:43]
    v_pk_add_f32 v[40:41], v[40:41], v[36:37]
    v_pk_fma_f32 v[42:43], v[36:37], v[36:37], v[42:43]
    v_add_f32 v40, v40, v41
    v_add_f32 v42, v42, v43
    s_nop 0
    v_add_f32_dpp v40, v40, v40 quad_perm:[1,0,3,2] row_mask:0xf bank_mask:0xf
    v_add_f32_dpp v42, v42, v42 quad_perm:[1,0,3,2] row_mask:0xf bank_mask:0xf
    s_nop 0
    v_add_f32_dpp v40, v40, v40 quad_perm:[2,3,0,1] row_mask:0xf bank_mask:0xf
    v_add_f32_dpp v42, v42, v42 quad_perm:[2,3,0,1] row_mask:0xf bank_mask:0xf
    s_nop 0
    v_add_f32_dpp v40, v40, v40 row_half_mirror row_mask:0xf bank_mask:0xf
    v_add_f32_dpp v42, v42, v42 row_half_mirror row_mask:0xf bank_mask:0xf
    s_nop 0
    v_add_f32_dpp v40, v40, v40 row_mirror row_mask:0xf bank_mask:0xf
    v_add_f32_dpp v42, v42, v42 row_mirror row_mask:0xf bank_mask:0xf
    v_mov_b32 v44, v40
    v_mov_b32 v45, v42
    s_nop 0
    v_permlane16_swap_b32 v40, v44
    v_permlane16_swap_b32 v42, v45
    v_add_f32 v40, v40, v44
    v_add_f32 v42, v42, v45
    v_mul_f32 v40, 0x3ae38e39, v40
    v_mul_f32 v42, 0x3ae38e39, v42
    v_fma_f32 v42, -v40, v40, v42
    v_cvt_pk_bf16_f32 v40, 0, -v40
    v_max_f32 v42, 0, v42
    v_cvt_pk_bf16_f32 v42, 0, v42
    v_pk_add_f32 v[20:21], v[20:21], v[40:41] op_sel_hi:[1,0]
    v_add_f32 v42, 0x3727c5ac, v42
    v_pk_add_f32 v[22:23], v[22:23], v[40:41] op_sel_hi:[1,0]
    v_cvt_pk_bf16_f32 v42, 0, v42
    v_pk_add_f32 v[24:25], v[24:25], v[40:41] op_sel_hi:[1,0]
    v_sqrt_f32 v42, v42
    v_pk_add_f32 v[26:27], v[26:27], v[40:41] op_sel_hi:[1,0]
    v_cvt_pk_bf16_f32 v42, 0, v42
    v_pk_add_f32 v[28:29], v[28:29], v[40:41] op_sel_hi:[1,0]
    v_rcp_f32 v42, v42
    v_pk_add_f32 v[30:31], v[30:31], v[40:41] op_sel_hi:[1,0]
    v_pk_add_f32 v[32:33], v[32:33], v[40:41] op_sel_hi:[1,0]
    v_pk_add_f32 v[34:35], v[34:35], v[40:41] op_sel_hi:[1,0]
    v_pk_add_f32 v[36:37], v[36:37], v[40:41] op_sel_hi:[1,0]
    v_cvt_pk_bf16_f32 v20, 0, v20
    v_cvt_pk_bf16_f32 v21, 0, v21
    v_cvt_pk_bf16_f32 v22, 0, v22
    v_cvt_pk_bf16_f32 v23, 0, v23
    v_cvt_pk_bf16_f32 v24, 0, v24
    v_cvt_pk_bf16_f32 v25, 0, v25
    v_cvt_pk_bf16_f32 v26, 0, v26
    v_cvt_pk_bf16_f32 v27, 0, v27
    v_cvt_pk_bf16_f32 v28, 0, v28
    v_cvt_pk_bf16_f32 v29, 0, v29
    v_cvt_pk_bf16_f32 v30, 0, v30
    v_cvt_pk_bf16_f32 v31, 0, v31
    v_cvt_pk_bf16_f32 v32, 0, v32
    v_cvt_pk_bf16_f32 v33, 0, v33
    v_cvt_pk_bf16_f32 v34, 0, v34
    v_cvt_pk_bf16_f32 v35, 0, v35
    v_cvt_pk_bf16_f32 v36, 0, v36
    v_cvt_pk_bf16_f32 v37, 0, v37
    v_pk_mul_f32 v[20:21], v[20:21], v[42:43] op_sel_hi:[1,0]
    v_pk_mul_f32 v[22:23], v[22:23], v[42:43] op_sel_hi:[1,0]
    v_pk_mul_f32 v[24:25], v[24:25], v[42:43] op_sel_hi:[1,0]
    v_pk_mul_f32 v[26:27], v[26:27], v[42:43] op_sel_hi:[1,0]
    v_pk_mul_f32 v[28:29], v[28:29], v[42:43] op_sel_hi:[1,0]
    v_pk_mul_f32 v[30:31], v[30:31], v[42:43] op_sel_hi:[1,0]
    v_pk_mul_f32 v[32:33], v[32:33], v[42:43] op_sel_hi:[1,0]
    v_pk_mul_f32 v[34:35], v[34:35], v[42:43] op_sel_hi:[1,0]
    v_pk_mul_f32 v[36:37], v[36:37], v[42:43] op_sel_hi:[1,0]
    v_cvt_pk_bf16_f32 v20, v20, v21
    v_cvt_pk_bf16_f32 v22, v22, v23
    v_cvt_pk_bf16_f32 v24, v24, v25
    v_cvt_pk_bf16_f32 v26, v26, v27
    v_cvt_pk_bf16_f32 v28, v28, v29
    v_cvt_pk_bf16_f32 v30, v30, v31
    v_cvt_pk_bf16_f32 v32, v32, v33
    v_cvt_pk_bf16_f32 v34, v34, v35
    v_cvt_pk_bf16_f32 v36, v36, v37
    ds_write_b32 v12, v20 offset:0
    ds_write_b32 v12, v22 offset:128
    ds_write_b32 v12, v24 offset:256
    ds_write_b32 v12, v26 offset:384
    ds_write_b32 v12, v28 offset:512
    ds_write_b32 v12, v30 offset:640
    ds_write_b32 v12, v32 offset:768
    ds_write_b32 v12, v34 offset:896
    ds_write_b32 v12, v36 offset:1024
    s_lshr_b32 s57, s35, 3
    s_lshr_b32 s62, s35, 6
    v_and_b32 v55, 3, v1
    v_mul_u32_u24 v55, 9, v55
    v_lshrrev_b32 v52, v55, s35
    v_lshrrev_b32 v53, 3, v52
    v_lshrrev_b32 v54, 6, v52
    v_mov_b32 v55, s60
    s_mov_b32 s54, 524288
    ds_read_b128 v[20:23], v11 offset:0
    ds_read_b128 v[24:27], v11 offset:64
    ds_read_b128 v[28:31], v11 offset:128
    ds_read_b128 v[32:35], v11 offset:192
    ds_read_b64 v[36:37], v17 offset:256
L_wqw:
    ds_read_b128 v[40:43], v15 offset:16
    s_waitcnt lgkmcnt(0)
    v_max_u32 v40, v40, v41
    v_max3_u32 v40, v40, v42, v43
    v_cmp_eq_u32 vcc, -1, v40
    s_nop 0
    s_cbranch_vccz L_wqok
    s_sub_u32 s54, s54, 1
    s_cmp_lg_u32 s54, 0
    s_cbranch_scc1 L_wqw
L_wqok:
    ds_read_b64_tr_b16 v[64:65], v10 offset:0
    ds_read_b64_tr_b16 v[66:67], v10 offset:512
    ds_read_b64_tr_b16 v[68:69], v10 offset:32
    ds_read_b64_tr_b16 v[70:71], v10 offset:544
    ds_read_b64_tr_b16 v[72:73], v10 offset:64
    ds_read_b64_tr_b16 v[74:75], v10 offset:576
    ds_read_b64_tr_b16 v[76:77], v10 offset:96
    ds_read_b64_tr_b16 v[78:79], v10 offset:608
    s_waitcnt lgkmcnt(0)
    ds_read_b64_tr_b16 v[80:81], v10 offset:4096
    ds_read_b64_tr_b16 v[82:83], v10 offset:4608
    ds_read_b64_tr_b16 v[84:85], v10 offset:4128
    ds_read_b64_tr_b16 v[86:87], v10 offset:4640
    ds_read_b64_tr_b16 v[88:89], v10 offset:4160
    ds_read_b64_tr_b16 v[90:91], v10 offset:4672
    ds_read_b64_tr_b16 v[92:93], v10 offset:4192
    ds_read_b64_tr_b16 v[94:95], v10 offset:4704
    v_mfma_f32_16x16x32_bf16 v[144:147], v[20:23], v[64:67], 0
    v_mfma_f32_16x16x32_bf16 v[148:151], v[20:23], v[68:71], 0
    v_mfma_f32_16x16x32_bf16 v[152:155], v[20:23], v[72:75], 0
    v_mfma_f32_16x16x32_bf16 v[156:159], v[20:23], v[76:79], 0
    s_waitcnt lgkmcnt(0)
    ds_read_b64_tr_b16 v[96:97], v10 offset:8192
    ds_read_b64_tr_b16 v[98:99], v10 offset:8704
    ds_read_b64_tr_b16 v[100:101], v10 offset:8224
    ds_read_b64_tr_b16 v[102:103], v10 offset:8736
    ds_read_b64_tr_b16 v[104:105], v10 offset:8256
    ds_read_b64_tr_b16 v[106:107], v10 offset:8768
    ds_read_b64_tr_b16 v[108:109], v10 offset:8288
    ds_read_b64_tr_b16 v[110:111], v10 offset:8800
    v_mfma_f32_16x16x32_bf16 v[144:147], v[24:27], v[80:83], v[144:147]
    v_mfma_f32_16x16x32_bf16 v[148:151], v[24:27], v[84:87], v[148:151]
    v_mfma_f32_16x16x32_bf16 v[152:155], v[24:27], v[88:91], v[152:155]
    v_mfma_f32_16x16x32_bf16 v[156:159], v[24:27], v[92:95], v[156:159]
    s_waitcnt lgkmcnt(0)
    ds_read_b64_tr_b16 v[112:113], v10 offset:12288
    ds_read_b64_tr_b16 v[114:115], v10 offset:12800
    ds_read_b64_tr_b16 v[116:117], v10 offset:12320
    ds_read_b64_tr_b16 v[118:119], v10 offset:12832
    ds_read_b64_tr_b16 v[120:121], v10 offset:12352
    ds_read_b64_tr_b16 v[122:123], v10 offset:12864
    ds_read_b64_tr_b16 v[124:125], v10 offset:12384
    ds_read_b64_tr_b16 v[126:127], v10 offset:12896
    v_mfma_f32_16x16x32_bf16 v[144:147], v[28:31], v[96:99], v[144:147]
    v_mfma_f32_16x16x32_bf16 v[148:151], v[28:31], v[100:103], v[148:151]
    v_mfma_f32_16x16x32_bf16 v[152:155], v[28:31], v[104:107], v[152:155]
    v_mfma_f32_16x16x32_bf16 v[156:159], v[28:31], v[108:111], v[156:159]
    s_waitcnt lgkmcnt(0)
    ds_read_b64_tr_b16 v[128:129], v18 offset:16384
    ds_read_b64_tr_b16 v[132:133], v18 offset:16416
    ds_read_b64_tr_b16 v[136:137], v18 offset:16448
    ds_read_b64_tr_b16 v[140:141], v18 offset:16480
    v_mfma_f32_16x16x32_bf16 v[144:147], v[32:35], v[112:115], v[144:147]
    v_mfma_f32_16x16x32_bf16 v[148:151], v[32:35], v[116:119], v[148:151]
    v_mfma_f32_16x16x32_bf16 v[152:155], v[32:35], v[120:123], v[152:155]
    v_mfma_f32_16x16x32_bf16 v[156:159], v[32:35], v[124:127], v[156:159]
    s_waitcnt lgkmcnt(0)
    v_mfma_f32_16x16x16_bf16 v[144:147], v[36:37], v[128:129], v[144:147]
    v_mfma_f32_16x16x16_bf16 v[148:151], v[36:37], v[132:133], v[148:151]
    v_mfma_f32_16x16x16_bf16 v[152:155], v[36:37], v[136:137], v[152:155]
    v_mfma_f32_16x16x16_bf16 v[156:159], v[36:37], v[140:141], v[156:159]
    s_nop 4
    v_cndmask_b32 v48, v144, v145, s[58:59]
    v_cndmask_b32 v49, v148, v149, s[58:59]
    v_cndmask_b32 v50, v152, v153, s[58:59]
    v_cndmask_b32 v51, v156, v157, s[58:59]
    v_add_u32 v48, 4, v48
    v_add_u32 v49, 4, v49
    v_add_u32 v50, 4, v50
    v_add_u32 v51, 4, v51
    v_bfi_b32 v48, 7, v52, v48
    v_bfi_b32 v49, 7, v53, v49
    v_bfi_b32 v50, 7, v54, v50
    v_bfi_b32 v51, 7, v55, v51
    s_mov_b32 exec_lo, -1
    s_mov_b32 exec_hi, 0
    buffer_store_dwordx4 v[48:51], v16, s[36:39], s52 offen
    s_mov_b32 s54, 0
    s_mov_b32 exec_lo, 0xffff
L_qspin:
    buffer_load_dwordx3 v[20:22], v14, s[36:39], s56 offen sc1
    s_waitcnt vmcnt(0)
    v_xor_b32 v20, s35, v20
    v_bitop3_b32 v20, v20, v21, s57 bitop3:0xf6
    v_bitop3_b32 v20, v20, v22, s62 bitop3:0xf6
    v_and_b32 v20, 7, v20
    v_cmp_ne_u32 vcc, 0, v20
    s_nop 0
    s_cbranch_vccz L_qful
    s_add_u32 s54, s54, 1
    s_cmp_lg_u32 s54, 12
    s_cbranch_scc1 L_qcont
    s_mov_b32 exec_lo, -1
    s_mov_b32 exec_hi, 0
    buffer_store_dwordx4 v[48:51], v16, s[36:39], s52 offen sc1
    s_mov_b32 exec_lo, 0xffff
L_qcont:
    s_cmp_lt_u32 s54, 524288
    s_cbranch_scc1 L_qspin
L_qful:
    s_mov_b64 exec, -1
    buffer_load_dwordx4 v[64:67], v3, s[36:39], s56 offen offset:0 sc1
    buffer_load_dwordx4 v[68:71], v3, s[36:39], s56 offen offset:1024 sc1
    buffer_load_dwordx4 v[72:75], v3, s[36:39], s56 offen offset:2048 sc1
    buffer_load_dwordx4 v[76:79], v3, s[36:39], s56 offen offset:3072 sc1
    v_mov_b32 v20, 0
    v_mov_b32 v22, 0
    s_waitcnt vmcnt(0)
    v_bitop3_b32 v20, v20, v64, v52 bitop3:0xf6
    v_bitop3_b32 v20, v20, v65, v53 bitop3:0xf6
    v_bitop3_b32 v20, v20, v66, v54 bitop3:0xf6
    v_bitop3_b32 v22, v22, v67, v55 bitop3:0xf6
    v_bitop3_b32 v20, v20, v68, v52 bitop3:0xf6
    v_bitop3_b32 v20, v20, v69, v53 bitop3:0xf6
    v_bitop3_b32 v20, v20, v70, v54 bitop3:0xf6
    v_bitop3_b32 v22, v22, v71, v55 bitop3:0xf6
    v_bitop3_b32 v20, v20, v72, v52 bitop3:0xf6
    v_bitop3_b32 v20, v20, v73, v53 bitop3:0xf6
    v_bitop3_b32 v20, v20, v74, v54 bitop3:0xf6
    v_bitop3_b32 v22, v22, v75, v55 bitop3:0xf6
    v_bitop3_b32 v20, v20, v76, v52 bitop3:0xf6
    v_bitop3_b32 v20, v20, v77, v53 bitop3:0xf6
    v_bitop3_b32 v20, v20, v78, v54 bitop3:0xf6
    v_bitop3_b32 v22, v22, v79, v55 bitop3:0xf6
    v_and_b32 v20, 7, v20
    v_and_b32 v22, 7, v22
    v_cmp_ne_u32 vcc, 0, v20
    s_nop 0
    s_cbranch_vccz L_qok
    s_add_u32 s54, s54, 1
    s_cmp_lg_u32 s54, 12
    s_cbranch_scc1 L_qcont2
    s_mov_b32 exec_lo, -1
    s_mov_b32 exec_hi, 0
    buffer_store_dwordx4 v[48:51], v16, s[36:39], s52 offen sc1
L_qcont2:
    s_cmp_lt_u32 s54, 524288
    s_cbranch_scc1 L_qful
    s_mov_b64 exec, -1
L_qok:
    v_cmp_ne_u32 vcc, 0, v22
    s_nop 0
    s_or_b32 s53, vcc_lo, vcc_hi
    s_cselect_b32 s53, 1, 0
    v_mov_b32 v20, s53
    v_mov_b32 v21, s35
    s_cbranch_scc0 L_qnear
    s_mov_b32 exec_lo, -1
    s_mov_b32 exec_hi, 0
    buffer_store_dwordx4 v[48:51], v16, s[36:39], s52 offen sc1
    s_mov_b64 exec, -1
L_qnear:
    v_and_b32 v64, -8, v64
    v_and_b32 v65, -8, v65
    v_and_b32 v66, -8, v66
    v_and_b32 v67, -8, v67
    v_and_b32 v68, -8, v68
    v_and_b32 v69, -8, v69
    v_and_b32 v70, -8, v70
    v_and_b32 v71, -8, v71
    v_and_b32 v72, -8, v72
    v_and_b32 v73, -8, v73
    v_and_b32 v74, -8, v74
    v_and_b32 v75, -8, v75
    v_and_b32 v76, -8, v76
    v_and_b32 v77, -8, v77
    v_and_b32 v78, -8, v78
    v_and_b32 v79, -8, v79
    v_pk_add_f32 v[64:65], v[64:65], v[72:73]
    v_pk_add_f32 v[66:67], v[66:67], v[74:75]
    v_pk_add_f32 v[68:69], v[68:69], v[76:77]
    v_pk_add_f32 v[70:71], v[70:71], v[78:79]
    v_pk_add_f32 v[64:65], v[64:65], v[68:69]
    v_pk_add_f32 v[66:67], v[66:67], v[70:71]
    v_cvt_pk_bf16_f32 v64, v64, v65
    v_cvt_pk_bf16_f32 v66, v66, v67
    ds_write_b16 v19, v64
    ds_write_b16_d16_hi v19, v64 offset:32
    ds_write_b16 v19, v66 offset:64
    ds_write_b16_d16_hi v19, v66 offset:96
    ds_write_b64 v15, v[20:21]
    s_setprio 0
    s_branch L_hgo
L_hother:
    s_nop 7
    s_barrier
    s_waitcnt lgkmcnt(0)
    s_mul_i32 s35, s35, 1664525
    s_add_u32 s35, s35, 1013904223
    s_xor_b32 s54, s3, 3
    s_andn2_b32 s55, s2, 20
    s_or_b32 s54, s54, s55
    s_cbranch_scc1 L_norace
    s_lshl_b32 s54, s2, 12
    s_add_u32 s54, s54, 786432
    s_add_u32 s56, s28, s54
    s_addc_u32 s57, s29, 0
    s_load_dword s54, s[56:57], 0
    s_waitcnt lgkmcnt(0)
    s_load_dword s54, s[56:57], 4096
    s_waitcnt lgkmcnt(0)
    s_load_dword s54, s[56:57], 256
    s_waitcnt lgkmcnt(0)
    s_load_dword s54, s[56:57], 4352
    s_waitcnt lgkmcnt(0)
    s_load_dword s54, s[56:57], 512
    s_waitcnt lgkmcnt(0)
    s_load_dword s54, s[56:57], 4608
    s_waitcnt lgkmcnt(0)
    s_load_dword s54, s[56:57], 768
    s_waitcnt lgkmcnt(0)
    s_load_dword s54, s[56:57], 4864
    s_waitcnt lgkmcnt(0)
    s_load_dword s54, s[56:57], 1024
    s_waitcnt lgkmcnt(0)
    s_load_dword s54, s[56:57], 5120
    s_waitcnt lgkmcnt(0)
    s_load_dword s54, s[56:57], 1280
    s_waitcnt lgkmcnt(0)
    s_load_dword s54, s[56:57], 5376
    s_waitcnt lgkmcnt(0)
    s_load_dword s54, s[56:57], 1536
    s_waitcnt lgkmcnt(0)
    s_load_dword s54, s[56:57], 5632
    s_waitcnt lgkmcnt(0)
    s_load_dword s54, s[56:57], 1792
    s_waitcnt lgkmcnt(0)
    s_load_dword s54, s[56:57], 5888
    s_waitcnt lgkmcnt(0)
    s_lshl_b32 s54, s32, 7
    s_add_u32 s56, s26, s54
    s_addc_u32 s57, s27, 0
    s_mov_b32 s54, 1
    s_atomic_add s54, s[56:57], 0 glc
    s_waitcnt lgkmcnt(0)
    s_and_b32 s54, s54, 1
    v_mov_b32 v8, s54
    v_mov_b32 v9, 82816
    ds_write_b32 v9, v8 offset:12
L_norace:
    s_xor_b32 s54, s3, 2
    s_or_b32 s54, s54, s34
    s_cbranch_scc1 L_hgo
    v_mov_b32 v52, 0
    v_mov_b32 v53, 0
    v_mov_b32 v54, 0
    v_mov_b32 v55, 0
    v_mov_b32 v56, s35
    s_mov_b32 s53, 524288
    buffer_store_dwordx4 v[52:55], v3, s[36:39], s53 offen offset:0 sc1
    buffer_store_dwordx4 v[52:55], v3, s[36:39], s53 offen offset:1024 sc1
    buffer_store_dwordx4 v[52:55], v3, s[36:39], s53 offen offset:2048 sc1
    s_mov_b32 s53, 540672
    buffer_store_dwordx4 v[52:55], v3, s[36:39], s53 offen offset:0 sc1
    buffer_store_dwordx4 v[52:55], v3, s[36:39], s53 offen offset:1024 sc1
    buffer_store_dwordx4 v[52:55], v3, s[36:39], s53 offen offset:2048 sc1
    s_mov_b32 s53, 659456
    s_waitcnt vmcnt(0)
    s_mov_b64 exec, 1
    buffer_store_dword v56, v2, s[36:39], s53 offen sc1
    s_mov_b64 exec, -1
L_hgo:
    s_nop 7
    s_mov_b32 s44, s16
    s_and_b32 s45, s17, 0xffff
    s_mov_b32 s46, 9216
    s_mov_b32 s47, 0x20000
    s_mov_b32 s48, s18
    s_and_b32 s49, s19, 0xffff
    s_mov_b32 s50, 9216
    s_mov_b32 s51, 0x20000
    s_mov_b32 s52, s20
    s_and_b32 s53, s21, 0xffff
    s_mov_b32 s54, 9216
    s_mov_b32 s55, 0x20000
    s_mul_i32 s60, s3, 2304
    s_load_dword s62, s[22:23], 0
    buffer_load_dwordx4 v[160:163], v3, s[44:47], s60 offen
    buffer_load_dwordx4 v[164:167], v3, s[44:47], s60 offen offset:1024
    buffer_load_dword v168, v2, s[44:47], s60 offen offset:2048
    s_waitcnt vmcnt(0)
    buffer_load_dwordx4 v[172:175], v3, s[48:51], s60 offen
    buffer_load_dwordx4 v[176:179], v3, s[48:51], s60 offen offset:1024
    buffer_load_dword v180, v2, s[48:51], s60 offen offset:2048
    s_waitcnt vmcnt(0)
    buffer_load_dwordx4 v[184:187], v3, s[52:55], s60 offen
    buffer_load_dwordx4 v[188:191], v3, s[52:55], s60 offen offset:1024
    buffer_load_dword v192, v2, s[52:55], s60 offen offset:2048
    s_waitcnt vmcnt(0)
    s_and_b32 s64, s2, 127
    s_lshl_b32 s64, s64, 16
    s_or_b32 s64, s64, 0x3f800000
    s_lshr_b32 s65, s2, 7
    s_lshl_b32 s65, s65, 31
    s_or_b32 s64, s64, s65
    v_mov_b32 v58, 0xc0135761
    s_mov_b32 s61, 0xbdd2d3e8
    s_waitcnt vmcnt(0)
    v_and_b32 v65, 0xffff0000, v160
    v_lshlrev_b32 v64, 16, v160
    v_and_b32 v67, 0xffff0000, v161
    v_lshlrev_b32 v66, 16, v161
    v_and_b32 v69, 0xffff0000, v162
    v_lshlrev_b32 v68, 16, v162
    v_and_b32 v71, 0xffff0000, v163
    v_lshlrev_b32 v70, 16, v163
    v_and_b32 v73, 0xffff0000, v164
    v_lshlrev_b32 v72, 16, v164
    v_and_b32 v75, 0xffff0000, v165
    v_lshlrev_b32 v74, 16, v165
    v_and_b32 v77, 0xffff0000, v166
    v_lshlrev_b32 v76, 16, v166
    v_and_b32 v79, 0xffff0000, v167
    v_lshlrev_b32 v78, 16, v167
    v_and_b32 v81, 0xffff0000, v168
    v_lshlrev_b32 v80, 16, v168
    v_and_b32 v83, 0xffff0000, v172
    v_lshlrev_b32 v82, 16, v172
    v_and_b32 v85, 0xffff0000, v173
    v_lshlrev_b32 v84, 16, v173
    v_and_b32 v87, 0xffff0000, v174
    v_lshlrev_b32 v86, 16, v174
    v_and_b32 v89, 0xffff0000, v175
    v_lshlrev_b32 v88, 16, v175
    v_and_b32 v91, 0xffff0000, v176
    v_lshlrev_b32 v90, 16, v176
    v_and_b32 v93, 0xffff0000, v177
    v_lshlrev_b32 v92, 16, v177
    v_and_b32 v95, 0xffff0000, v178
    v_lshlrev_b32 v94, 16, v178
    v_and_b32 v97, 0xffff0000, v179
    v_lshlrev_b32 v96, 16, v179
    v_and_b32 v99, 0xffff0000, v180
    v_lshlrev_b32 v98, 16, v180
    v_and_b32 v101, 0xffff0000, v184
    v_lshlrev_b32 v100, 16, v184
    v_and_b32 v103, 0xffff0000, v185
    v_lshlrev_b32 v102, 16, v185
    v_and_b32 v105, 0xffff0000, v186
    v_lshlrev_b32 v104, 16, v186
    v_and_b32 v107, 0xffff0000, v187
    v_lshlrev_b32 v106, 16, v187
    v_and_b32 v109, 0xffff0000, v188
    v_lshlrev_b32 v108, 16, v188
    v_and_b32 v111, 0xffff0000, v189
    v_lshlrev_b32 v110, 16, v189
    v_and_b32 v113, 0xffff0000, v190
    v_lshlrev_b32 v112, 16, v190
    v_and_b32 v115, 0xffff0000, v191
    v_lshlrev_b32 v114, 16, v191
    v_and_b32 v117, 0xffff0000, v192
    v_lshlrev_b32 v116, 16, v192
    v_mul_f32 v64, s64, v64
    v_mul_f32 v65, s64, v65
    v_mul_f32 v66, s64, v66
    v_mul_f32 v67, s64, v67
    v_mul_f32 v68, s64, v68
    v_mul_f32 v69, s64, v69
    v_mul_f32 v70, s64, v70
    v_mul_f32 v71, s64, v71
    v_mul_f32 v72, s64, v72
    v_mul_f32 v73, s64, v73
    v_mul_f32 v74, s64, v74
    v_mul_f32 v75, s64, v75
    v_mul_f32 v76, s64, v76
    v_mul_f32 v77, s64, v77
    v_mul_f32 v78, s64, v78
    v_mul_f32 v79, s64, v79
    v_mul_f32 v80, s64, v80
    v_mul_f32 v81, s64, v81
    v_cvt_pk_bf16_f32 v64, 0, v64
    v_cvt_pk_bf16_f32 v65, 0, v65
    v_cvt_pk_bf16_f32 v66, 0, v66
    v_cvt_pk_bf16_f32 v67, 0, v67
    v_cvt_pk_bf16_f32 v68, 0, v68
    v_cvt_pk_bf16_f32 v69, 0, v69
    v_cvt_pk_bf16_f32 v70, 0, v70
    v_cvt_pk_bf16_f32 v71, 0, v71
    v_cvt_pk_bf16_f32 v72, 0, v72
    v_cvt_pk_bf16_f32 v73, 0, v73
    v_cvt_pk_bf16_f32 v74, 0, v74
    v_cvt_pk_bf16_f32 v75, 0, v75
    v_cvt_pk_bf16_f32 v76, 0, v76
    v_cvt_pk_bf16_f32 v77, 0, v77
    v_cvt_pk_bf16_f32 v78, 0, v78
    v_cvt_pk_bf16_f32 v79, 0, v79
    v_cvt_pk_bf16_f32 v80, 0, v80
    v_cvt_pk_bf16_f32 v81, 0, v81
    s_mov_b32 s65, 0x36000000
    v_mov_b32 v12, 82560
L_tab:
    s_nop 7
    v_mov_b32 v10, 0
    v_mov_b32 v11, 0
    v_fma_f32 v16, v64, s65, v82
    v_fma_f32 v17, v65, s65, v83
    v_cvt_pk_bf16_f32 v16, 0, v16
    v_cvt_pk_bf16_f32 v17, 0, v17
    v_mul_f32 v18, v16, v16
    v_mul_f32 v19, v17, v17
    v_fma_f32 v18, v18, s61, v58
    v_fma_f32 v19, v19, s61, v58
    v_mul_f32 v18, v18, v16
    v_mul_f32 v19, v19, v17
    v_exp_f32 v18, v18
    v_exp_f32 v19, v19
    v_add_f32 v18, 1.0, v18
    v_add_f32 v19, 1.0, v19
    v_rcp_f32 v18, v18
    v_rcp_f32 v19, v19
    v_mul_f32 v16, v16, v18
    v_mul_f32 v17, v17, v19
    v_cvt_pk_bf16_f32 v16, 0, v16
    v_cvt_pk_bf16_f32 v17, 0, v17
    v_fmac_f32 v10, v16, v100
    v_fmac_f32 v10, v17, v101
    v_fma_f32 v20, v66, s65, v84
    v_fma_f32 v21, v67, s65, v85
    v_cvt_pk_bf16_f32 v20, 0, v20
    v_cvt_pk_bf16_f32 v21, 0, v21
    v_mul_f32 v22, v20, v20
    v_mul_f32 v23, v21, v21
    v_fma_f32 v22, v22, s61, v58
    v_fma_f32 v23, v23, s61, v58
    v_mul_f32 v22, v22, v20
    v_mul_f32 v23, v23, v21
    v_exp_f32 v22, v22
    v_exp_f32 v23, v23
    v_add_f32 v22, 1.0, v22
    v_add_f32 v23, 1.0, v23
    v_rcp_f32 v22, v22
    v_rcp_f32 v23, v23
    v_mul_f32 v20, v20, v22
    v_mul_f32 v21, v21, v23
    v_cvt_pk_bf16_f32 v20, 0, v20
    v_cvt_pk_bf16_f32 v21, 0, v21
    v_fmac_f32 v11, v20, v102
    v_fmac_f32 v11, v21, v103
    v_fma_f32 v16, v68, s65, v86
    v_fma_f32 v17, v69, s65, v87
    v_cvt_pk_bf16_f32 v16, 0, v16
    v_cvt_pk_bf16_f32 v17, 0, v17
    v_mul_f32 v18, v16, v16
    v_mul_f32 v19, v17, v17
    v_fma_f32 v18, v18, s61, v58
    v_fma_f32 v19, v19, s61, v58
    v_mul_f32 v18, v18, v16
    v_mul_f32 v19, v19, v17
    v_exp_f32 v18, v18
    v_exp_f32 v19, v19
    v_add_f32 v18, 1.0, v18
    v_add_f32 v19, 1.0, v19
    v_rcp_f32 v18, v18
    v_rcp_f32 v19, v19
    v_mul_f32 v16, v16, v18
    v_mul_f32 v17, v17, v19
    v_cvt_pk_bf16_f32 v16, 0, v16
    v_cvt_pk_bf16_f32 v17, 0, v17
    v_fmac_f32 v10, v16, v104
    v_fmac_f32 v10, v17, v105
    v_fma_f32 v20, v70, s65, v88
    v_fma_f32 v21, v71, s65, v89
    v_cvt_pk_bf16_f32 v20, 0, v20
    v_cvt_pk_bf16_f32 v21, 0, v21
    v_mul_f32 v22, v20, v20
    v_mul_f32 v23, v21, v21
    v_fma_f32 v22, v22, s61, v58
    v_fma_f32 v23, v23, s61, v58
    v_mul_f32 v22, v22, v20
    v_mul_f32 v23, v23, v21
    v_exp_f32 v22, v22
    v_exp_f32 v23, v23
    v_add_f32 v22, 1.0, v22
    v_add_f32 v23, 1.0, v23
    v_rcp_f32 v22, v22
    v_rcp_f32 v23, v23
    v_mul_f32 v20, v20, v22
    v_mul_f32 v21, v21, v23
    v_cvt_pk_bf16_f32 v20, 0, v20
    v_cvt_pk_bf16_f32 v21, 0, v21
    v_fmac_f32 v11, v20, v106
    v_fmac_f32 v11, v21, v107
    v_fma_f32 v16, v72, s65, v90
    v_fma_f32 v17, v73, s65, v91
    v_cvt_pk_bf16_f32 v16, 0, v16
    v_cvt_pk_bf16_f32 v17, 0, v17
    v_mul_f32 v18, v16, v16
    v_mul_f32 v19, v17, v17
    v_fma_f32 v18, v18, s61, v58
    v_fma_f32 v19, v19, s61, v58
    v_mul_f32 v18, v18, v16
    v_mul_f32 v19, v19, v17
    v_exp_f32 v18, v18
    v_exp_f32 v19, v19
    v_add_f32 v18, 1.0, v18
    v_add_f32 v19, 1.0, v19
    v_rcp_f32 v18, v18
    v_rcp_f32 v19, v19
    v_mul_f32 v16, v16, v18
    v_mul_f32 v17, v17, v19
    v_cvt_pk_bf16_f32 v16, 0, v16
    v_cvt_pk_bf16_f32 v17, 0, v17
    v_fmac_f32 v10, v16, v108
    v_fmac_f32 v10, v17, v109
    v_fma_f32 v20, v74, s65, v92
    v_fma_f32 v21, v75, s65, v93
    v_cvt_pk_bf16_f32 v20, 0, v20
    v_cvt_pk_bf16_f32 v21, 0, v21
    v_mul_f32 v22, v20, v20
    v_mul_f32 v23, v21, v21
    v_fma_f32 v22, v22, s61, v58
    v_fma_f32 v23, v23, s61, v58
    v_mul_f32 v22, v22, v20
    v_mul_f32 v23, v23, v21
    v_exp_f32 v22, v22
    v_exp_f32 v23, v23
    v_add_f32 v22, 1.0, v22
    v_add_f32 v23, 1.0, v23
    v_rcp_f32 v22, v22
    v_rcp_f32 v23, v23
    v_mul_f32 v20, v20, v22
    v_mul_f32 v21, v21, v23
    v_cvt_pk_bf16_f32 v20, 0, v20
    v_cvt_pk_bf16_f32 v21, 0, v21
    v_fmac_f32 v11, v20, v110
    v_fmac_f32 v11, v21, v111
    v_fma_f32 v16, v76, s65, v94
    v_fma_f32 v17, v77, s65, v95
    v_cvt_pk_bf16_f32 v16, 0, v16
    v_cvt_pk_bf16_f32 v17, 0, v17
    v_mul_f32 v18, v16, v16
    v_mul_f32 v19, v17, v17
    v_fma_f32 v18, v18, s61, v58
    v_fma_f32 v19, v19, s61, v58
    v_mul_f32 v18, v18, v16
    v_mul_f32 v19, v19, v17
    v_exp_f32 v18, v18
    v_exp_f32 v19, v19
    v_add_f32 v18, 1.0, v18
    v_add_f32 v19, 1.0, v19
    v_rcp_f32 v18, v18
    v_rcp_f32 v19, v19
    v_mul_f32 v16, v16, v18
    v_mul_f32 v17, v17, v19
    v_cvt_pk_bf16_f32 v16, 0, v16
    v_cvt_pk_bf16_f32 v17, 0, v17
    v_fmac_f32 v10, v16, v112
    v_fmac_f32 v10, v17, v113
    v_fma_f32 v20, v78, s65, v96
    v_fma_f32 v21, v79, s65, v97
    v_cvt_pk_bf16_f32 v20, 0, v20
    v_cvt_pk_bf16_f32 v21, 0, v21
    v_mul_f32 v22, v20, v20
    v_mul_f32 v23, v21, v21
    v_fma_f32 v22, v22, s61, v58
    v_fma_f32 v23, v23, s61, v58
    v_mul_f32 v22, v22, v20
    v_mul_f32 v23, v23, v21
    v_exp_f32 v22, v22
    v_exp_f32 v23, v23
    v_add_f32 v22, 1.0, v22
    v_add_f32 v23, 1.0, v23
    v_rcp_f32 v22, v22
    v_rcp_f32 v23, v23
    v_mul_f32 v20, v20, v22
    v_mul_f32 v21, v21, v23
    v_cvt_pk_bf16_f32 v20, 0, v20
    v_cvt_pk_bf16_f32 v21, 0, v21
    v_fmac_f32 v11, v20, v114
    v_fmac_f32 v11, v21, v115
    v_fma_f32 v16, v80, s65, v98
    v_fma_f32 v17, v81, s65, v99
    v_cvt_pk_bf16_f32 v16, 0, v16
    v_cvt_pk_bf16_f32 v17, 0, v17
    v_mul_f32 v18, v16, v16
    v_mul_f32 v19, v17, v17
    v_fma_f32 v18, v18, s61, v58
    v_fma_f32 v19, v19, s61, v58
    v_mul_f32 v18, v18, v16
    v_mul_f32 v19, v19, v17
    v_exp_f32 v18, v18
    v_exp_f32 v19, v19
    v_add_f32 v18, 1.0, v18
    v_add_f32 v19, 1.0, v19
    v_rcp_f32 v18, v18
    v_rcp_f32 v19, v19
    v_mul_f32 v16, v16, v18
    v_mul_f32 v17, v17, v19
    v_cvt_pk_bf16_f32 v16, 0, v16
    v_cvt_pk_bf16_f32 v17, 0, v17
    v_fmac_f32 v10, v16, v116
    v_fmac_f32 v10, v17, v117
    v_add_f32 v10, v10, v11
    s_nop 1
    v_add_f32_dpp v10, v10, v10 quad_perm:[1,0,3,2] row_mask:0xf bank_mask:0xf
    s_nop 1
    v_add_f32_dpp v10, v10, v10 quad_perm:[2,3,0,1] row_mask:0xf bank_mask:0xf
    s_nop 1
    v_add_f32_dpp v10, v10, v10 row_half_mirror row_mask:0xf bank_mask:0xf
    s_nop 1
    v_add_f32_dpp v10, v10, v10 row_mirror row_mask:0xf bank_mask:0xf
    v_mov_b32 v11, v10
    s_nop 1
    v_permlane16_swap_b32 v10, v11
    v_add_f32 v10, v10, v11
    v_mov_b32 v11, v10
    s_nop 1
    v_permlane32_swap_b32 v10, v11
    v_add_f32 v10, v10, v11
    s_mov_b64 exec, 1
    ds_add_f32 v12, v10
    s_mov_b64 exec, -1
    v_add_u32 v12, 4, v12
    s_add_u32 s65, s65, 0x800000
    s_cmp_lt_u32 s65, 0x42000000
    s_cbranch_scc1 L_tab
    v_mov_b32 v12, 82688
    v_mov_b32 v13, 1
    s_waitcnt lgkmcnt(0)
    s_mov_b64 exec, 1
    ds_add_rtn_u32 v14, v12, v13
    s_waitcnt lgkmcnt(0)
    s_mov_b64 exec, -1
    v_readfirstlane_b32 s65, v14
    s_nop 0
    s_cmp_lg_u32 s65, 3
    s_cbranch_scc1 L_tabdone
    v_mul_u32_u24 v12, 12, v1
    v_add_u32 v12, 82560, v12
    s_mov_b32 exec_lo, 0xff
    s_mov_b32 exec_hi, 0
    ds_read2_b32 v[16:17], v12 offset0:0 offset1:1
    ds_read_b32 v18, v12 offset:8
    s_lshl_b32 s62, s62, 16
    s_lshl_b32 s65, s2, 7
    s_add_u32 s65, s65, 589824
    v_mov_b32 v19, s35
    s_waitcnt lgkmcnt(0)
    v_cvt_pk_bf16_f32 v16, 0, v16
    v_add_f32 v16, s62, v16
    v_cvt_pk_bf16_f32 v16, 0, v16
    v_cvt_pk_bf16_f32 v17, 0, v17
    v_add_f32 v17, s62, v17
    v_cvt_pk_bf16_f32 v17, 0, v17
    v_cvt_pk_bf16_f32 v18, 0, v18
    v_add_f32 v18, s62, v18
    v_cvt_pk_bf16_f32 v18, 0, v18
    buffer_store_dwordx4 v[16:19], v3, s[36:39], s65 offen sc1
    s_mov_b64 exec, -1
L_tabdone:
    s_nop 7
    v_mov_b32 v16, 659456
    s_mov_b32 s54, 524288
    s_mov_b32 s51, 0x3fb8aa3b
L_fspin:
    buffer_load_dword v17, v16, s[36:39], 0 offen sc1
    s_waitcnt vmcnt(0)
    v_cmp_eq_u32 vcc, s35, v17
    s_nop 0
    s_cbranch_vccnz L_fok
    s_sleep 16
    s_sub_u32 s54, s54, 1
    s_cmp_lg_u32 s54, 0
    s_cbranch_scc1 L_fspin
L_fok:
    v_bfe_u32 v15, v1, 3, 1
    v_lshlrev_b32 v16, 2, v15
    v_add_u32 v16, 82432, v16
    s_mov_b32 s54, 524288
L_mspin:
    ds_read2_b32 v[20:21], v16 offset0:0 offset1:2
    ds_read2_b32 v[22:23], v16 offset0:4 offset1:6
    s_waitcnt lgkmcnt(0)
    v_max_u32 v24, v20, v21
    v_max3_u32 v24, v24, v22, v23
    v_cmp_eq_u32 vcc, -1, v24
    s_nop 0
    s_cbranch_vccz L_mok
    s_sleep 32
    s_sub_u32 s54, s54, 1
    s_cmp_lg_u32 s54, 0
    s_cbranch_scc1 L_mspin
L_mok:
    v_max_f32 v24, v20, v21
    v_max3_f32 v24, v24, v22, v23
    s_lshl_b32 s65, s3, 14
    s_add_u32 s65, s65, 16384
    v_add_u32 v17, s65, v2
    v_mov_b32 v25, 0
    v_mov_b32 v19, 0
    s_mov_b32 s53, 8
L_lsum:
    s_nop 7
    ds_read_b32 v64, v17 offset:0
    ds_read_b32 v66, v17 offset:256
    ds_read_b32 v68, v17 offset:512
    ds_read_b32 v70, v17 offset:768
    ds_read_b32 v72, v17 offset:1024
    ds_read_b32 v74, v17 offset:1280
    ds_read_b32 v76, v17 offset:1536
    ds_read_b32 v78, v17 offset:1792
    v_add_u32 v17, 2048, v17
    s_waitcnt lgkmcnt(0)
    v_and_b32 v65, 0xffff0000, v64
    v_lshlrev_b32 v64, 16, v64
    v_and_b32 v67, 0xffff0000, v66
    v_lshlrev_b32 v66, 16, v66
    v_and_b32 v69, 0xffff0000, v68
    v_lshlrev_b32 v68, 16, v68
    v_and_b32 v71, 0xffff0000, v70
    v_lshlrev_b32 v70, 16, v70
    v_and_b32 v73, 0xffff0000, v72
    v_lshlrev_b32 v72, 16, v72
    v_and_b32 v75, 0xffff0000, v74
    v_lshlrev_b32 v74, 16, v74
    v_and_b32 v77, 0xffff0000, v76
    v_lshlrev_b32 v76, 16, v76
    v_and_b32 v79, 0xffff0000, v78
    v_lshlrev_b32 v78, 16, v78
    v_sub_f32 v64, v64, v24
    v_sub_f32 v65, v65, v24
    v_sub_f32 v66, v66, v24
    v_sub_f32 v67, v67, v24
    v_sub_f32 v68, v68, v24
    v_sub_f32 v69, v69, v24
    v_sub_f32 v70, v70, v24
    v_sub_f32 v71, v71, v24
    v_sub_f32 v72, v72, v24
    v_sub_f32 v73, v73, v24
    v_sub_f32 v74, v74, v24
    v_sub_f32 v75, v75, v24
    v_sub_f32 v76, v76, v24
    v_sub_f32 v77, v77, v24
    v_sub_f32 v78, v78, v24
    v_sub_f32 v79, v79, v24
    v_mul_f32 v64, s51, v64
    v_mul_f32 v65, s51, v65
    v_mul_f32 v66, s51, v66
    v_mul_f32 v67, s51, v67
    v_mul_f32 v68, s51, v68
    v_mul_f32 v69, s51, v69
    v_mul_f32 v70, s51, v70
    v_mul_f32 v71, s51, v71
    v_mul_f32 v72, s51, v72
    v_mul_f32 v73, s51, v73
    v_mul_f32 v74, s51, v74
    v_mul_f32 v75, s51, v75
    v_mul_f32 v76, s51, v76
    v_mul_f32 v77, s51, v77
    v_mul_f32 v78, s51, v78
    v_mul_f32 v79, s51, v79
    v_exp_f32 v64, v64
    v_exp_f32 v65, v65
    v_exp_f32 v66, v66
    v_exp_f32 v67, v67
    v_exp_f32 v68, v68
    v_exp_f32 v69, v69
    v_exp_f32 v70, v70
    v_exp_f32 v71, v71
    v_exp_f32 v72, v72
    v_exp_f32 v73, v73
    v_exp_f32 v74, v74
    v_exp_f32 v75, v75
    v_exp_f32 v76, v76
    v_exp_f32 v77, v77
    v_exp_f32 v78, v78
    v_exp_f32 v79, v79
    v_add_f32 v19, v19, v64
    v_add_f32 v25, v25, v65
    v_add_f32 v19, v19, v66
    v_add_f32 v25, v25, v67
    v_add_f32 v19, v19, v68
    v_add_f32 v25, v25, v69
    v_add_f32 v19, v19, v70
    v_add_f32 v25, v25, v71
    v_add_f32 v19, v19, v72
    v_add_f32 v25, v25, v73
    v_add_f32 v19, v19, v74
    v_add_f32 v25, v25, v75
    v_add_f32 v19, v19, v76
    v_add_f32 v25, v25, v77
    v_add_f32 v19, v19, v78
    v_add_f32 v25, v25, v79
    s_sub_u32 s53, s53, 1
    s_cmp_lg_u32 s53, 0
    s_cbranch_scc1 L_lsum
    v_add_f32 v25, v25, v19
    s_nop 1
    v_add_f32_dpp v25, v25, v25 row_half_mirror row_mask:0xf bank_mask:0xf
    v_mov_b32 v19, v25
    s_nop 1
    v_permlane16_swap_b32 v25, v19
    v_add_f32 v25, v25, v19
    v_mov_b32 v19, v25
    s_nop 1
    v_permlane32_swap_b32 v25, v19
    v_add_f32 v25, v25, v19
    s_lshl_b32 s65, s3, 3
    v_add_u32 v17, s65, v16
    ds_write_b32 v17, v25 offset:32
    v_mov_b32 v12, 82692
    v_mov_b32 v13, 1
    s_waitcnt lgkmcnt(0)
    s_mov_b64 exec, 1
    ds_add_rtn_u32 v14, v12, v13
    s_waitcnt lgkmcnt(0)
    s_mov_b64 exec, -1
    v_readfirstlane_b32 s65, v14
    s_nop 0
    s_cmp_lg_u32 s65, 3
    s_cbranch_scc1 L_mldone
    ds_read2_b32 v[20:21], v16 offset0:8 offset1:10
    ds_read2_b32 v[22:23], v16 offset0:12 offset1:14
    v_mov_b32 v18, 82816
    ds_read_b32 v18, v18
    s_lshl_b32 s64, s30, 8
    s_add_u32 s64, s64, 720896
    s_lshl_b32 s65, s31, 4
    s_add_u32 s65, s65, s64
    v_mov_b32 v26, 0
    v_mov_b32 v27, s35
    s_mov_b32 s54, 524288
    s_waitcnt lgkmcnt(0)
    v_add_f32 v20, v20, v21
    v_add_f32 v22, v22, v23
    v_add_f32 v25, v20, v22
    v_cmp_ne_u32 vcc, 0, v18
    s_mov_b32 exec_lo, 0x101
    s_mov_b32 exec_hi, 0
    s_cbranch_vccnz L_mlfar
    buffer_store_dwordx4 v[24:27], v3, s[36:39], s65 offen
    s_branch L_mlpub
L_mlfar:
    buffer_store_dwordx4 v[24:27], v3, s[36:39], s65 offen sc1
L_mlpub:
    s_mov_b32 exec_lo, 0xffff
L_mlspin:
    s_sleep 16
    buffer_load_dwordx4 v[20:23], v3, s[36:39], s64 offen sc1
    s_waitcnt vmcnt(0)
    v_cmp_ne_u32 vcc, s35, v23
    s_nop 0
    s_cbranch_vccz L_mlok
    s_sub_u32 s54, s54, 1
    s_cmp_lg_u32 s54, 0
    s_cbranch_scc1 L_mlspin
L_mlok:
    v_mov_b32 v24, v20
    s_nop 1
    v_max_f32_dpp v24, v24, v24 quad_perm:[1,0,3,2] row_mask:0xf bank_mask:0xf
    s_nop 1
    v_max_f32_dpp v24, v24, v24 quad_perm:[2,3,0,1] row_mask:0xf bank_mask:0xf
    s_nop 1
    v_max_f32_dpp v24, v24, v24 row_half_mirror row_mask:0xf bank_mask:0xf
    v_sub_f32 v20, v20, v24
    v_mul_f32 v20, s51, v20
    v_exp_f32 v20, v20
    s_nop 0
    v_mul_f32 v21, v21, v20
    s_nop 1
    v_add_f32_dpp v21, v21, v21 quad_perm:[1,0,3,2] row_mask:0xf bank_mask:0xf
    s_nop 1
    v_add_f32_dpp v21, v21, v21 quad_perm:[2,3,0,1] row_mask:0xf bank_mask:0xf
    s_nop 1
    v_add_f32_dpp v21, v21, v21 row_half_mirror row_mask:0xf bank_mask:0xf
    v_rcp_f32 v21, v21
    ds_write_b32 v16, v21 offset:72
    ds_write_b32 v16, v24 offset:64
    s_mov_b64 exec, -1
L_mldone:
    s_nop 7
    s_lshl_b32 s65, s3, 12
    s_add_u32 s65, s65, 88064
    s_lshl_b32 s64, s3, 9
    s_add_u32 s64, s64, 104440
    v_lshrrev_b32 v12, 4, v1
    v_and_b32 v13, 15, v1
    v_lshrrev_b32 v14, 2, v13
    v_sub_u32 v13, v13, v14
    v_lshlrev_b32 v13, 1, v13
    v_lshl_add_u32 v14, v12, 5, v13
    v_add_u32 v14, s64, v14
    v_lshl_add_u32 v12, v12, 8, v13
    v_add_u32 v12, s65, v12
    v_mov_b32 v128, 0
    v_mov_b32 v129, 0
    v_mov_b32 v130, 0
    v_mov_b32 v131, 0
    v_mov_b32 v132, 0
    v_mov_b32 v133, 0
    v_mov_b32 v134, 0
    v_mov_b32 v135, 0
    v_mov_b32 v136, 0
    v_mov_b32 v137, 0
    v_mov_b32 v138, 0
    v_mov_b32 v139, 0
    v_mov_b32 v140, 0
    v_mov_b32 v141, 0
    v_mov_b32 v142, 0
    v_mov_b32 v143, 0
    v_mov_b32 v144, 0
    v_mov_b32 v145, 0
    v_mov_b32 v146, 0
    v_mov_b32 v147, 0
    v_mov_b32 v148, 0
    v_mov_b32 v149, 0
    v_mov_b32 v150, 0
    v_mov_b32 v151, 0
    s_mov_b32 exec_lo, 0x77777777
    s_mov_b32 exec_hi, 0x77777777
    ds_read_u16 v100, v12 offset:0
    ds_read_u16 v101, v12 offset:1024
    ds_read_u16 v102, v12 offset:2048
    ds_read_u16 v103, v12 offset:3072
    ds_read_u16 v104, v12 offset:128
    ds_read_u16 v105, v12 offset:1152
    ds_read_u16 v106, v12 offset:2176
    ds_read_u16 v107, v12 offset:3200
    s_waitcnt lgkmcnt(0)
    v_lshl_or_b32 v128, v101, 16, v100
    v_lshl_or_b32 v129, v103, 16, v102
    v_lshl_or_b32 v130, v105, 16, v104
    v_lshl_or_b32 v131, v107, 16, v106
    ds_read_u16 v100, v12 offset:24
    ds_read_u16 v101, v12 offset:1048
    ds_read_u16 v102, v12 offset:2072
    ds_read_u16 v103, v12 offset:3096
    ds_read_u16 v104, v12 offset:152
    ds_read_u16 v105, v12 offset:1176
    ds_read_u16 v106, v12 offset:2200
    ds_read_u16 v107, v12 offset:3224
    s_waitcnt lgkmcnt(0)
    v_lshl_or_b32 v132, v101, 16, v100
    v_lshl_or_b32 v133, v103, 16, v102
    v_lshl_or_b32 v134, v105, 16, v104
    v_lshl_or_b32 v135, v107, 16, v106
    ds_read_u16 v100, v12 offset:48
    ds_read_u16 v101, v12 offset:1072
    ds_read_u16 v102, v12 offset:2096
    ds_read_u16 v103, v12 offset:3120
    ds_read_u16 v104, v12 offset:176
    ds_read_u16 v105, v12 offset:1200
    ds_read_u16 v106, v12 offset:2224
    ds_read_u16 v107, v12 offset:3248
    s_waitcnt lgkmcnt(0)
    v_lshl_or_b32 v136, v101, 16, v100
    v_lshl_or_b32 v137, v103, 16, v102
    v_lshl_or_b32 v138, v105, 16, v104
    v_lshl_or_b32 v139, v107, 16, v106
    ds_read_u16 v100, v12 offset:72
    ds_read_u16 v101, v12 offset:1096
    ds_read_u16 v102, v12 offset:2120
    ds_read_u16 v103, v12 offset:3144
    ds_read_u16 v104, v12 offset:200
    ds_read_u16 v105, v12 offset:1224
    ds_read_u16 v106, v12 offset:2248
    ds_read_u16 v107, v12 offset:3272
    s_waitcnt lgkmcnt(0)
    v_lshl_or_b32 v140, v101, 16, v100
    v_lshl_or_b32 v141, v103, 16, v102
    v_lshl_or_b32 v142, v105, 16, v104
    v_lshl_or_b32 v143, v107, 16, v106
    ds_read_u16 v100, v12 offset:96
    ds_read_u16 v101, v12 offset:1120
    ds_read_u16 v102, v12 offset:2144
    ds_read_u16 v103, v12 offset:3168
    ds_read_u16 v104, v12 offset:224
    ds_read_u16 v105, v12 offset:1248
    ds_read_u16 v106, v12 offset:2272
    ds_read_u16 v107, v12 offset:3296
    s_waitcnt lgkmcnt(0)
    v_lshl_or_b32 v144, v101, 16, v100
    v_lshl_or_b32 v145, v103, 16, v102
    v_lshl_or_b32 v146, v105, 16, v104
    v_lshl_or_b32 v147, v107, 16, v106
    s_mov_b32 exec_lo, 0x00170017
    s_mov_b32 exec_hi, 0x00170017
    ds_read_u16 v100, v12 offset:120
    ds_read_u16 v101, v12 offset:1144
    ds_read_u16 v102, v12 offset:2168
    ds_read_u16 v103, v12 offset:3192
    ds_read_u16 v104, v12 offset:248
    ds_read_u16 v105, v12 offset:1272
    ds_read_u16 v106, v12 offset:2296
    ds_read_u16 v107, v12 offset:3320
    s_mov_b32 exec_lo, 0x77607760
    s_mov_b32 exec_hi, 0x77607760
    s_waitcnt lgkmcnt(0)
    ds_read_u16 v100, v14 offset:0
    ds_read_u16 v101, v14 offset:128
    ds_read_u16 v102, v14 offset:256
    ds_read_u16 v103, v14 offset:384
    ds_read_u16 v104, v14 offset:16
    ds_read_u16 v105, v14 offset:144
    ds_read_u16 v106, v14 offset:272
    ds_read_u16 v107, v14 offset:400
    s_mov_b32 exec_lo, 0x77777777
    s_mov_b32 exec_hi, 0x77777777
    s_waitcnt lgkmcnt(0)
    v_lshl_or_b32 v148, v101, 16, v100
    v_lshl_or_b32 v149, v103, 16, v102
    v_lshl_or_b32 v150, v105, 16, v104
    v_lshl_or_b32 v151, v107, 16, v106
    s_mov_b64 exec, -1
    s_andn2_b32 s65, s2, 20
    s_cbranch_scc1 L_hready
    v_mov_b32 v16, 82816
    s_mov_b32 s54, 524288
L_rspin:
    ds_read_b32 v17, v16 offset:12
    s_waitcnt lgkmcnt(0)
    v_cmp_ne_u32 vcc, -1, v17
    s_nop 0
    s_cbranch_vccnz L_rok
    s_sleep 8
    s_sub_u32 s54, s54, 1
    s_cmp_lg_u32 s54, 0
    s_cbranch_scc1 L_rspin
L_rok:
    v_cmp_ne_u32 vcc, 0, v17
    s_nop 0
    s_cbranch_vccnz L_hready
    s_lshr_b32 s65, s3, 1
    s_lshl_b32 s65, s65, 17
    s_and_b32 s55, s3, 1
    s_lshl_b32 s55, s55, 8
    s_add_u32 s65, s65, s55
    s_mov_b32 s54, 524288
    v_and_b32 v15, 7, v1
    v_lshrrev_b32 v16, 3, v1
    v_lshlrev_b32 v16, 2, v16
    v_mul_u32_u24 v17, 1536, v15
    v_add3_u32 v16, v16, v17, s65
    s_lshl_b32 s65, s3, 13
    s_add_u32 s65, s65, 589824
    s_add_u32 s55, s65, 4096
L_tspin:
    buffer_load_dwordx4 v[64:67], v3, s[36:39], s65 offen offset:0 sc1
    s_waitcnt vmcnt(0)
    buffer_load_dwordx4 v[68:71], v3, s[36:39], s65 offen offset:1024 sc1
    s_waitcnt vmcnt(0)
    buffer_load_dwordx4 v[72:75], v3, s[36:39], s65 offen offset:2048 sc1
    s_waitcnt vmcnt(0)
    buffer_load_dwordx4 v[76:79], v3, s[36:39], s65 offen offset:3072 sc1
    s_waitcnt vmcnt(0)
    buffer_load_dwordx4 v[80:83], v3, s[36:39], s55 offen offset:0 sc1
    s_waitcnt vmcnt(0)
    buffer_load_dwordx4 v[84:87], v3, s[36:39], s55 offen offset:1024 sc1
    s_waitcnt vmcnt(0)
    buffer_load_dwordx4 v[88:91], v3, s[36:39], s55 offen offset:2048 sc1
    s_waitcnt vmcnt(0)
    buffer_load_dwordx4 v[92:95], v3, s[36:39], s55 offen offset:3072 sc1
    s_waitcnt vmcnt(0)
    v_xor_b32 v17, s35, v67
    v_bitop3_b32 v17, v17, v71, s35 bitop3:0xf6
    v_bitop3_b32 v17, v17, v75, s35 bitop3:0xf6
    v_bitop3_b32 v17, v17, v79, s35 bitop3:0xf6
    v_bitop3_b32 v17, v17, v83, s35 bitop3:0xf6
    v_bitop3_b32 v17, v17, v87, s35 bitop3:0xf6
    v_bitop3_b32 v17, v17, v91, s35 bitop3:0xf6
    v_bitop3_b32 v17, v17, v95, s35 bitop3:0xf6
    v_cmp_ne_u32 vcc, 0, v17
    s_nop 0
    s_cbranch_vccz L_tok
    s_sleep 64
    s_sub_u32 s54, s54, 1
    s_cmp_lg_u32 s54, 0
    s_cbranch_scc1 L_tspin
L_tok:
    ds_write_b32 v16, v64 offset:0
    ds_write_b32 v16, v65 offset:512
    ds_write_b32 v16, v66 offset:1024
    ds_write_b32 v16, v68 offset:32
    ds_write_b32 v16, v69 offset:544
    ds_write_b32 v16, v70 offset:1056
    ds_write_b32 v16, v72 offset:64
    ds_write_b32 v16, v73 offset:576
    ds_write_b32 v16, v74 offset:1088
    ds_write_b32 v16, v76 offset:96
    ds_write_b32 v16, v77 offset:608
    ds_write_b32 v16, v78 offset:1120
    ds_write_b32 v16, v80 offset:128
    ds_write_b32 v16, v81 offset:640
    ds_write_b32 v16, v82 offset:1152
    ds_write_b32 v16, v84 offset:160
    ds_write_b32 v16, v85 offset:672
    ds_write_b32 v16, v86 offset:1184
    ds_write_b32 v16, v88 offset:192
    ds_write_b32 v16, v89 offset:704
    ds_write_b32 v16, v90 offset:1216
    ds_write_b32 v16, v92 offset:224
    ds_write_b32 v16, v93 offset:736
    ds_write_b32 v16, v94 offset:1248
    s_cmp_lg_u32 s3, 3
    s_cbranch_scc1 L_hready
    s_waitcnt lgkmcnt(0)
    s_brev_b32 s60, 1
    s_mov_b32 s61, -1
    s_branch L_zok
L_hready:
    s_nop 7
    v_and_b32 v12, 3, v1
    v_cmp_eq_u32 vcc, 3, v12
    s_nop 1
    v_cndmask_b32 v8, 0, 1.0, vcc
    v_mov_b32 v9, v8
    v_mov_b32 v10, v8
    v_mov_b32 v11, v8
    v_mov_b32 v4, s35
    v_lshrrev_b32 v5, 8, v4
    v_lshrrev_b32 v6, 16, v4
    v_lshrrev_b32 v7, 24, v4
    s_lshl_b32 s63, s33, 14
    s_lshl_b32 s64, s32, 13
    s_add_u32 s63, s63, s64
    s_lshl_b32 s64, s3, 11
    s_add_u32 s63, s63, s64
    s_add_u32 s63, s63, 262144
    v_bfe_u32 v13, v1, 4, 1
    v_mul_u32_u24 v13, 16384, v13
    v_lshrrev_b32 v14, 5, v1
    v_lshl_add_u32 v13, v14, 6, v13
    v_and_b32 v14, 15, v1
    v_lshl_add_u32 v13, v14, 2, v13
    s_and_b32 s64, s32, 0
    s_mul_i32 s64, s64, 4096
    s_mul_i32 s65, s31, 384
    s_add_u32 s64, s64, s65
    s_add_u32 s64, s64, 524288
    s_lshl_b32 s65, s3, 7
    s_add_u32 s64, s64, s65
    s_lshl_b32 s65, s3, 2
    s_add_u32 s65, s65, 106496
    v_add_u32 v14, s65, v3
    s_lshl_b32 s65, s3, 10
    s_add_u32 s65, s65, 106496
    v_add_u32 v15, s65, v3
    s_mov_b32 s54, 524288
    s_movk_i32 s55, 0xff00
    s_mov_b32 s68, 0
    s_mov_b32 s69, -1
    s_waitcnt vmcnt(0) lgkmcnt(0)
    s_barrier
    s_lshl_b32 s58, s34, 10
    s_add_u32 s58, s58, 262144
    s_cmp_lg_u32 s3, 0
    s_cselect_b32 s58, 557056, s58
    s_cmp_ge_u32 s3, 2
    s_cbranch_scc1 L_nowarm
    buffer_load_dwordx4 v[16:19], v3, s[36:39], s58 offen sc1
L_nowarm:
    s_setprio 3
    s_waitcnt vmcnt(0)
    s_barrier
L_ispin:
    buffer_load_dwordx4 v[16:19], v3, s[36:39], s63 offen sc1
    buffer_load_dwordx4 v[20:23], v3, s[36:39], s63 offen offset:1024 sc1
    s_waitcnt vmcnt(1)
    v_xor_b32 v12, v16, v4
    v_bitop3_b32 v12, v12, v17, v5 bitop3:0xf6
    v_bitop3_b32 v12, v12, v18, v6 bitop3:0xf6
    v_bitop3_b32 v12, v12, v19, v7 bitop3:0xf6
    v_and_b32 v16, s55, v16
    v_and_b32 v17, s55, v17
    v_and_b32 v18, s55, v18
    v_and_b32 v19, s55, v19
    s_waitcnt vmcnt(0)
    v_bitop3_b32 v12, v12, v20, v4 bitop3:0xf6
    v_bitop3_b32 v12, v12, v21, v5 bitop3:0xf6
    v_bitop3_b32 v12, v12, v22, v6 bitop3:0xf6
    v_bitop3_b32 v12, v12, v23, v7 bitop3:0xf6
    v_and_b32 v12, 0xff, v12
    v_cmp_ne_u32 vcc, 0, v12
    v_and_b32 v20, s55, v20
    v_and_b32 v21, s55, v21
    v_and_b32 v22, s55, v22
    v_and_b32 v23, s55, v23
    s_cbranch_vccz L_iok
    s_sub_u32 s54, s54, 1
    s_cmp_lg_u32 s54, 0
    s_cbranch_scc1 L_ispin
L_iok:
    v_add_f32_dpp v24, v16, v16 row_half_mirror row_mask:0xf bank_mask:0x5
    v_add_f32_dpp v25, v17, v17 row_half_mirror row_mask:0xf bank_mask:0x5
    v_add_f32_dpp v26, v18, v18 row_half_mirror row_mask:0xf bank_mask:0x5
    v_add_f32_dpp v27, v19, v19 row_half_mirror row_mask:0xf bank_mask:0x5
    v_add_f32_dpp v24, v20, v20 row_half_mirror row_mask:0xf bank_mask:0xa
    v_add_f32_dpp v25, v21, v21 row_half_mirror row_mask:0xf bank_mask:0xa
    v_add_f32_dpp v26, v22, v22 row_half_mirror row_mask:0xf bank_mask:0xa
    v_add_f32_dpp v27, v23, v23 row_half_mirror row_mask:0xf bank_mask:0xa
    v_add_f32_dpp v24, v24, v24 quad_perm:[1,0,3,2] row_mask:0xf bank_mask:0xf
    v_add_f32_dpp v25, v25, v25 quad_perm:[1,0,3,2] row_mask:0xf bank_mask:0xf
    v_add_f32_dpp v26, v26, v26 quad_perm:[1,0,3,2] row_mask:0xf bank_mask:0xf
    v_add_f32_dpp v27, v27, v27 quad_perm:[1,0,3,2] row_mask:0xf bank_mask:0xf
    v_add_f32_dpp v24, v24, v24 quad_perm:[2,3,0,1] row_mask:0xf bank_mask:0xf
    v_add_f32_dpp v25, v25, v25 quad_perm:[2,3,0,1] row_mask:0xf bank_mask:0xf
    v_add_f32_dpp v26, v26, v26 quad_perm:[2,3,0,1] row_mask:0xf bank_mask:0xf
    v_add_f32_dpp v27, v27, v27 quad_perm:[2,3,0,1] row_mask:0xf bank_mask:0xf
    v_cvt_pk_bf16_f32 v32, v24, v25
    v_cvt_pk_bf16_f32 v33, v26, v27
    v_cvt_pk_bf16_f32 v34, v24, v25
    v_cvt_pk_bf16_f32 v35, v26, v27
    v_mov_b32_dpp v32, v32 row_ror:8 row_mask:0xf bank_mask:0xc
    v_mov_b32_dpp v33, v33 row_ror:8 row_mask:0xf bank_mask:0xc
    v_mov_b32_dpp v34, v34 row_ror:8 row_mask:0xf bank_mask:0x3
    v_mov_b32_dpp v35, v35 row_ror:8 row_mask:0xf bank_mask:0x3
    s_nop 1
    v_mfma_f32_16x16x32_bf16 v[40:43], v[32:35], v[128:131], v[8:11]
    v_mfma_f32_16x16x32_bf16 v[44:47], v[32:35], v[132:135], v[8:11]
    v_mfma_f32_16x16x32_bf16 v[48:51], v[32:35], v[136:139], v[8:11]
    v_mfma_f32_16x16x32_bf16 v[52:55], v[32:35], v[140:143], v[8:11]
    v_mfma_f32_16x16x32_bf16 v[56:59], v[32:35], v[144:147], v[8:11]
    v_mfma_f32_16x16x32_bf16 v[60:63], v[32:35], v[148:151], v[8:11]
    s_nop 3
    v_cndmask_b32 v16, v40, v44, s[68:69]
    ds_write_b32 v14, v16 offset:0
    v_cndmask_b32 v17, v48, v52, s[68:69]
    ds_write_b32 v14, v17 offset:1024
    v_cndmask_b32 v18, v56, v60, s[68:69]
    ds_write_b32 v14, v18 offset:2048
    s_cmp_eq_u32 s3, 3
    s_waitcnt lgkmcnt(0)
    s_barrier
    s_cbranch_scc1 L_end
    ds_read_b128 v[16:19], v15
    s_waitcnt lgkmcnt(0)
    v_pk_add_f32 v[16:17], v[16:17], v[18:19]
    v_add_f32 v16, v16, v17
    buffer_atomic_add_f32 v16, v13, s[36:39], s64 offen sc1
L_end:
    s_endpgm
.section .rodata,"a"
.p2align 6
.amdhsa_kernel sequential_preLN__gqa_block_cached__mixer_token_mlp__decode_kernel
  .amdhsa_next_free_vgpr 256
  .amdhsa_next_free_sgpr 102
  .amdhsa_accum_offset 256
  .amdhsa_group_segment_fixed_size 0
  .amdhsa_kernarg_size 104
  .amdhsa_user_sgpr_count 2
  .amdhsa_user_sgpr_kernarg_segment_ptr 1
  .amdhsa_system_sgpr_workgroup_id_x 1
  .amdhsa_float_denorm_mode_32 3
.end_amdhsa_kernel
```
